```python
import torch

def _softmax(x, axis=-1):
    return torch.softmax(x, dim=axis)
def _gelu(x):
    return torch.nn.functional.gelu(x, approximate="tanh")
def _silu(x):
    return torch.nn.functional.silu(x)
def _sigmoid(x):
    return torch.sigmoid(x)
def _layernorm(x, axis=-1, eps=1e-5):
    m = x.mean(dim=axis, keepdim=True)
    v = x.var(dim=axis, keepdim=True, unbiased=False)
    return (x - m) / torch.sqrt(v + eps)
def _scatter_add(tgt, idx, src, axis=0):
    return tgt.clone().index_add_(axis, idx, src)
def _segment_sum(src, seg, n):
    out = torch.zeros((n,) + src.shape[1:], dtype=src.dtype)
    return out.index_add_(0, seg, src)
def _pad(x, pw):
    flat = tuple(v for pair in reversed(pw) for v in pair)
    return torch.nn.functional.pad(x, flat)

kernel_name = 'parallel_sum__spectral_gfnet__mixer_token_mlp__prompt'

def setup_inputs():

    _w = (lambda a: (lambda t: t.to(torch.bfloat16) if t.is_floating_point() else t)(torch.as_tensor(a)))
    def _A_setup():
        B, S, D = 1, 2048, 576
        Df = D // 2 + 1
        return {
            "x": _w((lambda *s: torch.randn(*s, dtype=torch.bfloat16) * 0.05)(B, S, D)),
            "w_r": _w((lambda *s: torch.randn(*s, dtype=torch.bfloat16) * 3.2)(S, Df) * 0.02),
            "w_i": _w((lambda *s: torch.randn(*s, dtype=torch.bfloat16) * 3.2)(S, Df) * 0.02),
        }
    _A_in = _A_setup()

    def _B_setup():
        B, S, D, F = 1, 2048, 576, 4608
        return {
            "x": _w((lambda *s: torch.randn(*s, dtype=torch.bfloat16) * 0.05)(B, S, D)),
            "w1": _w((lambda *s: torch.randn(*s, dtype=torch.bfloat16) * 0.4)(S, F) * (S ** -0.5)),
            "b1": _w((lambda *s: torch.randn(*s, dtype=torch.bfloat16) * 3.2)(F) * 0.02),
            "w2": _w((lambda *s: torch.randn(*s, dtype=torch.bfloat16) * 0.8)(F, S) * (F ** -0.5)),
            "b2": _w((lambda *s: torch.randn(*s, dtype=torch.bfloat16) * 3.2)(S) * 0.02),
        }
    _B_in = _B_setup()

    return {
        "A_x": _A_in["x"],
        "A_w_r": _A_in["w_r"],
        "A_w_i": _A_in["w_i"],
        "B_x": _B_in["x"],
        "B_w1": _B_in["w1"],
        "B_b1": _B_in["b1"],
        "B_w2": _B_in["w2"],
        "B_b2": _B_in["b2"],
    }

def reference(A_x, A_w_r, A_w_i, B_x, B_w1, B_b1, B_w2, B_b2):
    def _A_ref(x, w_r, w_i):
        B, S, D = x.shape
        X = (lambda x, axes=(-2,-1): torch.fft.rfft2(x.float(), dim=axes))(x, axes=(-2, -1))
        W = w_r + 1j * w_i
        X = X * W
        y = (lambda x, s, axes=(-2,-1): torch.fft.irfft2(x, s=s, dim=axes).to(torch.bfloat16))(X, (S, D), axes=(-2, -1))
        return y

    def _B_ref(x, w1, b1, w2, b2):
        B, S, D = x.shape
        h = _layernorm(x, axis=-1)
        u = torch.einsum("bsd,sf->bdf", h, w1) + b1
        u = _gelu(u)
        y = torch.einsum("bdf,fs->bds", u, w2) + b2
        return (lambda x, *d: x.permute(*d))(y, 0, 2, 1)

    x = A_x
    xn = _layernorm(x, axis=-1)
    return x + _A_ref(xn, A_w_r, A_w_i) + _B_ref(xn, B_w1, B_b1, B_w2, B_b2)
```

```asm
; @launch kernel=k1_kernel grid=(256,1,1) block=(832,1,1) lds=11264
; @launch kernel=k2_kernel grid=(256,1,1) block=(512,1,1) lds=157696
; @launch kernel=k3_kernel grid=(256,1,1) block=(512,1,1) lds=156672
.amdgcn_target "amdgcn-amd-amdhsa--gfx950"
.text
.globl k1_kernel
.p2align 8
.type k1_kernel,@function
k1_kernel:
    s_cmp_ge_u32 s2, 256
    s_cbranch_scc1 K1_END
    s_load_dwordx2 s[4:5], s[0:1], 0
    s_load_dwordx4 s[8:11], s[0:1], 8
    s_load_dwordx2 s[6:7], s[0:1], 80
    s_load_dwordx2 s[44:45], s[0:1], 32
    v_and_b32 v1, 63, v0
    v_lshrrev_b32 v2, 6, v0
    s_nop 0
    v_readfirstlane_b32 s3, v2
    s_lshr_b32 s28, s2, 5
    s_and_b32 s29, s2, 31
    s_lshr_b32 s30, s28, 1
    s_and_b32 s31, s28, 1
    s_lshl_b32 s30, s30, 3
    s_lshl_b32 s31, s31, 1
    s_add_u32 s30, s30, s31
    s_bfe_u32 s31, s3, 0x10001
    s_lshl_b32 s31, s31, 2
    s_add_u32 s30, s30, s31
    s_and_b32 s31, s3, 1
    s_add_u32 s30, s30, s31
    s_lshl_b32 s30, s30, 6
    s_lshl_b32 s31, s29, 1
    s_add_u32 s30, s30, s31
    s_lshr_b32 s31, s3, 2
    s_add_u32 s30, s30, s31
    s_mul_i32 s43, s30, 192
    s_mul_i32 s30, s30, 1152
    v_lshlrev_b32 v3, 2, v1
    s_waitcnt lgkmcnt(0)
    s_mov_b32 s12, s4
    s_mov_b32 s13, s5
    s_mov_b32 s14, 2359296
    s_mov_b32 s15, 0x00020000
    s_mov_b32 s16, s8
    s_mov_b32 s17, s9
    s_mov_b32 s18, 1183744
    s_mov_b32 s19, 0x00020000
    s_mov_b32 s20, s10
    s_mov_b32 s21, s11
    s_mov_b32 s22, 1183744
    s_mov_b32 s23, 0x00020000
    s_mov_b32 s24, s6
    s_mov_b32 s25, s7
    s_mov_b32 s26, 15728640
    s_mov_b32 s27, 0x00020000
    s_mov_b32 s48, s44
    s_mov_b32 s49, s45
    s_mov_b32 s50, 18874368
    s_mov_b32 s51, 0x00020000
    v_mov_b32 v14, 0
    s_cmp_ge_u32 s3, 8
    s_cbranch_scc1 K1_NOX
    buffer_load_dword v10, v3, s[12:15], s30 offen offset:0
    buffer_load_dword v11, v3, s[12:15], s30 offen offset:256
    buffer_load_dword v12, v3, s[12:15], s30 offen offset:512
    buffer_load_dword v13, v3, s[12:15], s30 offen offset:768
    s_mov_b64 exec, 0xffffffff
    buffer_load_dword v14, v3, s[12:15], s30 offen offset:1024
    s_mov_b64 exec, -1
K1_NOX:
    s_and_b32 s32, s2, 15
    s_lshr_b32 s33, s2, 4
    s_lshl_b32 s34, s32, 1
    s_lshl_b32 s35, s33, 7
    s_add_u32 s34, s34, s35
    s_mul_i32 s34, s34, 578
    v_lshlrev_b32 v5, 1, v0
    s_cmp_ge_u32 s3, 5
    s_cbranch_scc1 K1_NOW
    v_cmp_gt_u32 vcc, 289, v0
    s_nop 3
    s_and_saveexec_b64 s[36:37], vcc
    s_add_u32 s35, s34, 0
    buffer_load_ushort v20, v5, s[16:19], s35 offen nt
    buffer_load_ushort v28, v5, s[20:23], s35 offen nt
    s_add_u32 s35, s34, 18496
    buffer_load_ushort v21, v5, s[16:19], s35 offen nt
    buffer_load_ushort v29, v5, s[20:23], s35 offen nt
    s_add_u32 s35, s34, 36992
    buffer_load_ushort v22, v5, s[16:19], s35 offen nt
    buffer_load_ushort v30, v5, s[20:23], s35 offen nt
    s_add_u32 s35, s34, 55488
    buffer_load_ushort v23, v5, s[16:19], s35 offen nt
    buffer_load_ushort v31, v5, s[20:23], s35 offen nt
    s_add_u32 s35, s34, 578
    buffer_load_ushort v24, v5, s[16:19], s35 offen nt
    buffer_load_ushort v32, v5, s[20:23], s35 offen nt
    s_add_u32 s35, s34, 19074
    buffer_load_ushort v25, v5, s[16:19], s35 offen nt
    buffer_load_ushort v33, v5, s[20:23], s35 offen nt
    s_add_u32 s35, s34, 37570
    buffer_load_ushort v26, v5, s[16:19], s35 offen nt
    buffer_load_ushort v34, v5, s[20:23], s35 offen nt
    s_add_u32 s35, s34, 56066
    buffer_load_ushort v27, v5, s[16:19], s35 offen nt
    buffer_load_ushort v35, v5, s[20:23], s35 offen nt
    s_mov_b64 exec, s[36:37]
K1_NOW:
    s_cmp_lt_u32 s3, 8
    s_cbranch_scc1 K1_LNROLE
K1_NOPF:
    v_and_b32 v6, 15, v1
    v_lshrrev_b32 v7, 4, v1
    s_sub_u32 s35, s3, 8
    s_lshl_b32 s35, s35, 4
    v_add_u32 v8, s35, v6
    v_cvt_f32_u32 v86, v8
    v_mul_f32 v86, 0x3be38e39, v86
    v_cvt_f32_u32 v87, v7
    v_mul_f32 v87, v87, v86
    v_add_f32 v87, v87, v87
    v_fmamk_f32 v88, v86, 0x00000000, v87
    v_fract_f32 v88, v88
    v_cos_f32 v89, v88
    v_sin_f32 v90, v88
    v_mul_f32 v92, 0x3d2aaaab, v89
    v_mul_f32 v93, 0x3d2aaaab, v90
    v_fmamk_f32 v88, v86, 0x42000000, v87
    v_fract_f32 v88, v88
    v_cos_f32 v89, v88
    v_sin_f32 v90, v88
    v_mul_f32 v89, 0x3d2aaaab, v89
    v_mul_f32 v90, 0x3d2aaaab, v90
    v_cvt_pk_f16_f32 v40, v92, v89
    v_cvt_pk_f16_f32 v60, v93, v90
    v_fmamk_f32 v88, v86, 0x42800000, v87
    v_fract_f32 v88, v88
    v_cos_f32 v89, v88
    v_sin_f32 v90, v88
    v_mul_f32 v92, 0x3d2aaaab, v89
    v_mul_f32 v93, 0x3d2aaaab, v90
    v_fmamk_f32 v88, v86, 0x42c00000, v87
    v_fract_f32 v88, v88
    v_cos_f32 v89, v88
    v_sin_f32 v90, v88
    v_mul_f32 v89, 0x3d2aaaab, v89
    v_mul_f32 v90, 0x3d2aaaab, v90
    v_cvt_pk_f16_f32 v41, v92, v89
    v_cvt_pk_f16_f32 v61, v93, v90
    v_fmamk_f32 v88, v86, 0x3f800000, v87
    v_fract_f32 v88, v88
    v_cos_f32 v89, v88
    v_sin_f32 v90, v88
    v_mul_f32 v92, 0x3d2aaaab, v89
    v_mul_f32 v93, 0x3d2aaaab, v90
    v_fmamk_f32 v88, v86, 0x42040000, v87
    v_fract_f32 v88, v88
    v_cos_f32 v89, v88
    v_sin_f32 v90, v88
    v_mul_f32 v89, 0x3d2aaaab, v89
    v_mul_f32 v90, 0x3d2aaaab, v90
    v_cvt_pk_f16_f32 v42, v92, v89
    v_cvt_pk_f16_f32 v62, v93, v90
    v_fmamk_f32 v88, v86, 0x42820000, v87
    v_fract_f32 v88, v88
    v_cos_f32 v89, v88
    v_sin_f32 v90, v88
    v_mul_f32 v92, 0x3d2aaaab, v89
    v_mul_f32 v93, 0x3d2aaaab, v90
    v_fmamk_f32 v88, v86, 0x42c20000, v87
    v_fract_f32 v88, v88
    v_cos_f32 v89, v88
    v_sin_f32 v90, v88
    v_mul_f32 v89, 0x3d2aaaab, v89
    v_mul_f32 v90, 0x3d2aaaab, v90
    v_cvt_pk_f16_f32 v43, v92, v89
    v_cvt_pk_f16_f32 v63, v93, v90
    v_fmamk_f32 v88, v86, 0x41000000, v87
    v_fract_f32 v88, v88
    v_cos_f32 v89, v88
    v_sin_f32 v90, v88
    v_mul_f32 v92, 0x3d2aaaab, v89
    v_mul_f32 v93, 0x3d2aaaab, v90
    v_fmamk_f32 v88, v86, 0x42200000, v87
    v_fract_f32 v88, v88
    v_cos_f32 v89, v88
    v_sin_f32 v90, v88
    v_mul_f32 v89, 0x3d2aaaab, v89
    v_mul_f32 v90, 0x3d2aaaab, v90
    v_cvt_pk_f16_f32 v44, v92, v89
    v_cvt_pk_f16_f32 v64, v93, v90
    v_fmamk_f32 v88, v86, 0x42900000, v87
    v_fract_f32 v88, v88
    v_cos_f32 v89, v88
    v_sin_f32 v90, v88
    v_mul_f32 v92, 0x3d2aaaab, v89
    v_mul_f32 v93, 0x3d2aaaab, v90
    v_fmamk_f32 v88, v86, 0x42d00000, v87
    v_fract_f32 v88, v88
    v_cos_f32 v89, v88
    v_sin_f32 v90, v88
    v_mul_f32 v89, 0x3d2aaaab, v89
    v_mul_f32 v90, 0x3d2aaaab, v90
    v_cvt_pk_f16_f32 v45, v92, v89
    v_cvt_pk_f16_f32 v65, v93, v90
    v_fmamk_f32 v88, v86, 0x41100000, v87
    v_fract_f32 v88, v88
    v_cos_f32 v89, v88
    v_sin_f32 v90, v88
    v_mul_f32 v92, 0x3d2aaaab, v89
    v_mul_f32 v93, 0x3d2aaaab, v90
    v_fmamk_f32 v88, v86, 0x42240000, v87
    v_fract_f32 v88, v88
    v_cos_f32 v89, v88
    v_sin_f32 v90, v88
    v_mul_f32 v89, 0x3d2aaaab, v89
    v_mul_f32 v90, 0x3d2aaaab, v90
    v_cvt_pk_f16_f32 v46, v92, v89
    v_cvt_pk_f16_f32 v66, v93, v90
    v_fmamk_f32 v88, v86, 0x42920000, v87
    v_fract_f32 v88, v88
    v_cos_f32 v89, v88
    v_sin_f32 v90, v88
    v_mul_f32 v92, 0x3d2aaaab, v89
    v_mul_f32 v93, 0x3d2aaaab, v90
    v_fmamk_f32 v88, v86, 0x42d20000, v87
    v_fract_f32 v88, v88
    v_cos_f32 v89, v88
    v_sin_f32 v90, v88
    v_mul_f32 v89, 0x3d2aaaab, v89
    v_mul_f32 v90, 0x3d2aaaab, v90
    v_cvt_pk_f16_f32 v47, v92, v89
    v_cvt_pk_f16_f32 v67, v93, v90
    v_fmamk_f32 v88, v86, 0x41800000, v87
    v_fract_f32 v88, v88
    v_cos_f32 v89, v88
    v_sin_f32 v90, v88
    v_mul_f32 v92, 0x3d2aaaab, v89
    v_mul_f32 v93, 0x3d2aaaab, v90
    v_fmamk_f32 v88, v86, 0x42400000, v87
    v_fract_f32 v88, v88
    v_cos_f32 v89, v88
    v_sin_f32 v90, v88
    v_mul_f32 v89, 0x3d2aaaab, v89
    v_mul_f32 v90, 0x3d2aaaab, v90
    v_cvt_pk_f16_f32 v48, v92, v89
    v_cvt_pk_f16_f32 v68, v93, v90
    v_fmamk_f32 v88, v86, 0x42a00000, v87
    v_fract_f32 v88, v88
    v_cos_f32 v89, v88
    v_sin_f32 v90, v88
    v_mul_f32 v92, 0x3d2aaaab, v89
    v_mul_f32 v93, 0x3d2aaaab, v90
    v_fmamk_f32 v88, v86, 0x42e00000, v87
    v_fract_f32 v88, v88
    v_cos_f32 v89, v88
    v_sin_f32 v90, v88
    v_mul_f32 v89, 0x3d2aaaab, v89
    v_mul_f32 v90, 0x3d2aaaab, v90
    v_cvt_pk_f16_f32 v49, v92, v89
    v_cvt_pk_f16_f32 v69, v93, v90
    v_fmamk_f32 v88, v86, 0x41880000, v87
    v_fract_f32 v88, v88
    v_cos_f32 v89, v88
    v_sin_f32 v90, v88
    v_mul_f32 v92, 0x3d2aaaab, v89
    v_mul_f32 v93, 0x3d2aaaab, v90
    v_fmamk_f32 v88, v86, 0x42440000, v87
    v_fract_f32 v88, v88
    v_cos_f32 v89, v88
    v_sin_f32 v90, v88
    v_mul_f32 v89, 0x3d2aaaab, v89
    v_mul_f32 v90, 0x3d2aaaab, v90
    v_cvt_pk_f16_f32 v50, v92, v89
    v_cvt_pk_f16_f32 v70, v93, v90
    v_fmamk_f32 v88, v86, 0x42a20000, v87
    v_fract_f32 v88, v88
    v_cos_f32 v89, v88
    v_sin_f32 v90, v88
    v_mul_f32 v92, 0x3d2aaaab, v89
    v_mul_f32 v93, 0x3d2aaaab, v90
    v_fmamk_f32 v88, v86, 0x42e20000, v87
    v_fract_f32 v88, v88
    v_cos_f32 v89, v88
    v_sin_f32 v90, v88
    v_mul_f32 v89, 0x3d2aaaab, v89
    v_mul_f32 v90, 0x3d2aaaab, v90
    v_cvt_pk_f16_f32 v51, v92, v89
    v_cvt_pk_f16_f32 v71, v93, v90
    v_fmamk_f32 v88, v86, 0x41c00000, v87
    v_fract_f32 v88, v88
    v_cos_f32 v89, v88
    v_sin_f32 v90, v88
    v_mul_f32 v92, 0x3d2aaaab, v89
    v_mul_f32 v93, 0x3d2aaaab, v90
    v_fmamk_f32 v88, v86, 0x42600000, v87
    v_fract_f32 v88, v88
    v_cos_f32 v89, v88
    v_sin_f32 v90, v88
    v_mul_f32 v89, 0x3d2aaaab, v89
    v_mul_f32 v90, 0x3d2aaaab, v90
    v_cvt_pk_f16_f32 v52, v92, v89
    v_cvt_pk_f16_f32 v72, v93, v90
    v_fmamk_f32 v88, v86, 0x42b00000, v87
    v_fract_f32 v88, v88
    v_cos_f32 v89, v88
    v_sin_f32 v90, v88
    v_mul_f32 v92, 0x3d2aaaab, v89
    v_mul_f32 v93, 0x3d2aaaab, v90
    v_fmamk_f32 v88, v86, 0x42f00000, v87
    v_fract_f32 v88, v88
    v_cos_f32 v89, v88
    v_sin_f32 v90, v88
    v_mul_f32 v89, 0x3d2aaaab, v89
    v_mul_f32 v90, 0x3d2aaaab, v90
    v_cvt_pk_f16_f32 v53, v92, v89
    v_cvt_pk_f16_f32 v73, v93, v90
    v_fmamk_f32 v88, v86, 0x41c80000, v87
    v_fract_f32 v88, v88
    v_cos_f32 v89, v88
    v_sin_f32 v90, v88
    v_mul_f32 v92, 0x3d2aaaab, v89
    v_mul_f32 v93, 0x3d2aaaab, v90
    v_fmamk_f32 v88, v86, 0x42640000, v87
    v_fract_f32 v88, v88
    v_cos_f32 v89, v88
    v_sin_f32 v90, v88
    v_mul_f32 v89, 0x3d2aaaab, v89
    v_mul_f32 v90, 0x3d2aaaab, v90
    v_cvt_pk_f16_f32 v54, v92, v89
    v_cvt_pk_f16_f32 v74, v93, v90
    v_fmamk_f32 v88, v86, 0x42b20000, v87
    v_fract_f32 v88, v88
    v_cos_f32 v89, v88
    v_sin_f32 v90, v88
    v_mul_f32 v92, 0x3d2aaaab, v89
    v_mul_f32 v93, 0x3d2aaaab, v90
    v_fmamk_f32 v88, v86, 0x42f20000, v87
    v_fract_f32 v88, v88
    v_cos_f32 v89, v88
    v_sin_f32 v90, v88
    v_mul_f32 v89, 0x3d2aaaab, v89
    v_mul_f32 v90, 0x3d2aaaab, v90
    v_cvt_pk_f16_f32 v55, v92, v89
    v_cvt_pk_f16_f32 v75, v93, v90
    v_add_f32 v88, v87, v87
    v_fmamk_f32 v88, v86, 0x43000000, v88
    v_fract_f32 v88, v88
    v_cos_f32 v89, v88
    v_sin_f32 v90, v88
    v_mul_f32 v92, 0x3d2aaaab, v89
    v_mul_f32 v93, 0x3d2aaaab, v90
    v_cvt_pk_f16_f32 v56, v92, 0
    v_cvt_pk_f16_f32 v76, v93, 0
    v_add_f32 v88, v87, v87
    v_fmamk_f32 v88, v86, 0x43010000, v88
    v_fract_f32 v88, v88
    v_cos_f32 v89, v88
    v_sin_f32 v90, v88
    v_mul_f32 v92, 0x3d2aaaab, v89
    v_mul_f32 v93, 0x3d2aaaab, v90
    v_cvt_pk_f16_f32 v57, v92, 0
    v_cvt_pk_f16_f32 v77, v93, 0
    v_add_f32 v88, v87, v87
    v_fmamk_f32 v88, v86, 0x43020000, v88
    v_fract_f32 v88, v88
    v_cos_f32 v89, v88
    v_sin_f32 v90, v88
    v_mul_f32 v92, 0x3d2aaaab, v89
    v_mul_f32 v93, 0x3d2aaaab, v90
    v_cvt_pk_f16_f32 v58, v92, 0
    v_cvt_pk_f16_f32 v78, v93, 0
    v_add_f32 v88, v87, v87
    v_fmamk_f32 v88, v86, 0x43030000, v88
    v_fract_f32 v88, v88
    v_cos_f32 v89, v88
    v_sin_f32 v90, v88
    v_mul_f32 v92, 0x3d2aaaab, v89
    v_mul_f32 v93, 0x3d2aaaab, v90
    v_cvt_pk_f16_f32 v59, v92, 0
    v_cvt_pk_f16_f32 v79, v93, 0
    v_mul_f32 v88, 0x3e800000, v86
    v_fract_f32 v88, v88
    v_cos_f32 v80, v88
    v_sin_f32 v81, v88
    v_mul_f32 v88, 0x3f000000, v86
    v_fract_f32 v88, v88
    v_cos_f32 v82, v88
    v_sin_f32 v83, v88
    v_mul_f32 v88, 0x3f400000, v86
    v_fract_f32 v88, v88
    v_cos_f32 v84, v88
    v_sin_f32 v85, v88
    s_branch K1_NOLN
K1_LNROLE:
    s_cmp_ge_u32 s2, 192
    s_cbranch_scc1 K1_TABS
    v_cmp_gt_u32 vcc, 288, v0
    s_nop 3
    s_and_saveexec_b64 s[36:37], vcc
    s_cbranch_execz K1_GDONE
    s_mul_i32 s38, s2, 3
    v_cmp_eq_u32 vcc, 0, v0
    s_mov_b32 s40, 7456541
    s_mov_b32 s41, 576
    v_lshlrev_b32 v9, 2, v0
    s_add_u32 s39, s38, 0
    v_mul_u32_u24 v89, s39, v0
    v_mul_hi_u32 v90, v89, s40
    v_mul_u32_u24 v90, s41, v90
    v_sub_u32 v89, v89, v90
    v_cvt_f32_u32 v88, v89
    v_mul_f32 v88, 0x3ae38e39, v88
    v_cos_f32 v89, v88
    v_sin_f32 v90, v88
    v_mul_f32 v89, 0x3daaaaab, v89
    v_mul_f32 v90, 0x3daaaaab, v90
    v_cvt_pk_f16_f32 v89, v89, v90
    s_and_b32 s42, s39, 1
    s_lshl_b32 s42, s42, 31
    s_or_b32 s42, s42, 0x29552955
    v_mov_b32 v90, s42
    v_cndmask_b32 v89, v89, v90, vcc
    s_mul_i32 s42, s39, 10368
    s_add_u32 s42, s42, 7208960
    buffer_store_dword v89, v9, s[24:27], s42 offen
    s_add_u32 s39, s38, 1
    v_mul_u32_u24 v89, s39, v0
    v_mul_hi_u32 v90, v89, s40
    v_mul_u32_u24 v90, s41, v90
    v_sub_u32 v89, v89, v90
    v_cvt_f32_u32 v88, v89
    v_mul_f32 v88, 0x3ae38e39, v88
    v_cos_f32 v89, v88
    v_sin_f32 v90, v88
    v_mul_f32 v89, 0x3daaaaab, v89
    v_mul_f32 v90, 0x3daaaaab, v90
    v_cvt_pk_f16_f32 v89, v89, v90
    s_and_b32 s42, s39, 1
    s_lshl_b32 s42, s42, 31
    s_or_b32 s42, s42, 0x29552955
    v_mov_b32 v90, s42
    v_cndmask_b32 v89, v89, v90, vcc
    s_mul_i32 s42, s39, 10368
    s_add_u32 s42, s42, 7208960
    buffer_store_dword v89, v9, s[24:27], s42 offen
    s_add_u32 s39, s38, 2
    v_mul_u32_u24 v89, s39, v0
    v_mul_hi_u32 v90, v89, s40
    v_mul_u32_u24 v90, s41, v90
    v_sub_u32 v89, v89, v90
    v_cvt_f32_u32 v88, v89
    v_mul_f32 v88, 0x3ae38e39, v88
    v_cos_f32 v89, v88
    v_sin_f32 v90, v88
    v_mul_f32 v89, 0x3daaaaab, v89
    v_mul_f32 v90, 0x3daaaaab, v90
    v_cvt_pk_f16_f32 v89, v89, v90
    s_and_b32 s42, s39, 1
    s_lshl_b32 s42, s42, 31
    s_or_b32 s42, s42, 0x29552955
    v_mov_b32 v90, s42
    v_cndmask_b32 v89, v89, v90, vcc
    s_mul_i32 s42, s39, 10368
    s_add_u32 s42, s42, 7208960
    buffer_store_dword v89, v9, s[24:27], s42 offen
K1_GDONE:
    s_mov_b64 exec, s[36:37]
    s_branch K1_TABDONE
K1_TABS:
    s_cmp_ge_u32 s3, 4
    s_cbranch_scc1 K1_TABDONE
    s_sub_u32 s38, s2, 192
    s_lshl_b32 s38, s38, 8
    v_add_u32 v9, s38, v0
    v_and_b32 v92, 31, v1
    v_lshrrev_b32 v93, 5, v1
    s_cmp_ge_u32 s2, 200
    s_cbranch_scc1 K1_TF64
    v_and_b32 v94, 3, v9
    v_bfe_u32 v95, v9, 2, 6
    v_bfe_u32 v96, v9, 8, 2
    v_lshrrev_b32 v97, 10, v9
    v_lshlrev_b32 v89, 3, v96
    v_lshrrev_b32 v90, 1, v94
    v_lshl_add_u32 v89, v90, 2, v89
    v_lshrrev_b32 v90, 5, v95
    v_lshl_add_u32 v89, v90, 1, v89
    v_and_b32 v90, 1, v94
    v_add_u32 v89, v89, v90
    v_bfe_u32 v90, v95, 1, 4
    v_lshl_add_u32 v90, v97, 4, v90
    v_mul_u32_u24 v89, v89, v90
    v_and_b32 v89, 31, v89
    v_cvt_f32_u32 v88, v89
    v_mul_f32 v88, 0x3d000000, v88
    v_cos_f32 v89, v88
    v_sin_f32 v90, v88
    v_mul_f32 v89, 0x3e3504f3, v89
    v_mul_f32 v90, 0x3e3504f3, v90
    v_cvt_pk_f16_f32 v96, v89, v90
    v_sub_f32 v90, 0, v90
    v_cvt_pk_f16_f32 v97, v90, v89
    v_and_b32 v95, 1, v95
    v_cmp_eq_u32 vcc, 1, v95
    s_nop 1
    v_cndmask_b32 v96, v96, v97, vcc
    v_lshlrev_b32 v89, 2, v9
    s_mov_b32 s38, 15597568
    buffer_store_dword v96, v89, s[24:27], s38 offen
    s_branch K1_TABDONE
K1_TF64:
    s_cmp_ge_u32 s2, 216
    s_cbranch_scc1 K1_TTW1
    v_subrev_u32 v9, 2048, v9
    v_and_b32 v94, 3, v9
    v_bfe_u32 v95, v9, 2, 6
    v_bfe_u32 v96, v9, 8, 2
    v_bfe_u32 v97, v9, 10, 1
    v_and_b32 v89, 31, v95
    v_lshl_add_u32 v89, v97, 5, v89
    v_lshlrev_b32 v90, 4, v96
    v_lshrrev_b32 v91, 1, v94
    v_lshl_add_u32 v90, v91, 3, v90
    v_lshrrev_b32 v91, 5, v95
    v_lshl_add_u32 v90, v91, 2, v90
    v_and_b32 v91, 1, v94
    v_lshl_add_u32 v90, v91, 1, v90
    v_mul_u32_u24 v90, v90, v89
    v_add_u32 v91, v90, v89
    v_and_b32 v90, 63, v90
    v_and_b32 v91, 63, v91
    v_cvt_f32_u32 v90, v90
    v_cvt_f32_u32 v91, v91
    v_mul_f32 v90, 0x3c800000, v90
    v_mul_f32 v91, 0x3c800000, v91
    v_lshrrev_b32 v97, 11, v9
    v_cvt_f32_u32 v97, v97
    v_fmamk_f32 v90, v97, 0xbe800000, v90
    v_fmamk_f32 v91, v97, 0xbe800000, v91
    v_cos_f32 v90, v90
    v_cos_f32 v91, v91
    v_mul_f32 v90, 0x3e000000, v90
    v_mul_f32 v91, 0x3e000000, v91
    v_cvt_pk_f16_f32 v90, v90, v91
    v_lshlrev_b32 v89, 2, v9
    s_mov_b32 s38, 15605760
    buffer_store_dword v90, v89, s[24:27], s38 offen
    s_branch K1_TABDONE
K1_TTW1:
    s_cmp_ge_u32 s2, 224
    s_cbranch_scc1 K1_TTW2
    v_subrev_u32 v9, 6144, v9
    v_bfe_u32 v94, v9, 6, 3
    v_bfe_u32 v95, v9, 9, 1
    v_bfe_u32 v96, v9, 10, 1
    v_bfe_u32 v89, v1, 1, 4
    v_lshl_add_u32 v89, v95, 4, v89
    v_lshlrev_b32 v90, 5, v96
    v_lshrrev_b32 v91, 1, v94
    v_lshl_add_u32 v90, v91, 3, v90
    v_lshl_add_u32 v90, v93, 2, v90
    v_and_b32 v91, 1, v94
    v_lshl_add_u32 v90, v91, 1, v90
    v_mul_u32_u24 v90, v90, v89
    v_add_u32 v91, v90, v89
    v_cvt_f32_u32 v90, v90
    v_cvt_f32_u32 v91, v91
    v_mul_f32 v90, 0x3a000000, v90
    v_mul_f32 v91, 0x3a000000, v91
    v_cos_f32 v100, v90
    v_sin_f32 v101, v90
    v_cos_f32 v102, v91
    v_sin_f32 v103, v91
    v_lshlrev_b32 v94, 31, v1
    v_xor_b32 v101, v101, v94
    v_xor_b32 v103, v103, v94
    v_lshlrev_b32 v89, 4, v9
    s_mov_b32 s38, 15622144
    buffer_store_dwordx4 v[100:103], v89, s[24:27], s38 offen
    s_branch K1_TABDONE
K1_TTW2:
    s_cmp_ge_u32 s2, 228
    s_cbranch_scc1 K1_TABDONE
    v_subrev_u32 v9, 8192, v9
    v_bfe_u32 v94, v9, 6, 2
    v_bfe_u32 v95, v9, 8, 1
    v_bfe_u32 v96, v9, 9, 1
    v_lshl_add_u32 v89, v95, 5, v92
    v_lshlrev_b32 v90, 4, v96
    v_lshl_add_u32 v90, v94, 2, v90
    v_lshl_add_u32 v90, v93, 1, v90
    v_mul_u32_u24 v90, v90, v89
    v_add_u32 v91, v90, v89
    v_cvt_f32_u32 v90, v90
    v_cvt_f32_u32 v91, v91
    v_mul_f32 v90, 0x3a000000, v90
    v_mul_f32 v91, 0x3a000000, v91
    v_cos_f32 v100, v90
    v_sin_f32 v101, v90
    v_cos_f32 v102, v91
    v_sin_f32 v103, v91
    v_lshlrev_b32 v89, 4, v9
    s_mov_b32 s38, 15654912
    buffer_store_dwordx4 v[100:103], v89, s[24:27], s38 offen
K1_TABDONE:
    s_waitcnt vmcnt(0)
    s_cmp_ge_u32 s3, 5
    s_cbranch_scc1 K1_LN
    v_cmp_gt_u32 vcc, 289, v0
    s_nop 3
    s_and_saveexec_b64 s[36:37], vcc
    v_lshlrev_b32 v20, 16, v20
    v_lshlrev_b32 v28, 16, v28
    v_lshlrev_b32 v21, 16, v21
    v_lshlrev_b32 v29, 16, v29
    v_lshlrev_b32 v22, 16, v22
    v_lshlrev_b32 v30, 16, v30
    v_lshlrev_b32 v23, 16, v23
    v_lshlrev_b32 v31, 16, v31
    v_lshlrev_b32 v24, 16, v24
    v_lshlrev_b32 v32, 16, v32
    v_lshlrev_b32 v25, 16, v25
    v_lshlrev_b32 v33, 16, v33
    v_lshlrev_b32 v26, 16, v26
    v_lshlrev_b32 v34, 16, v34
    v_lshlrev_b32 v27, 16, v27
    v_lshlrev_b32 v35, 16, v35
    v_cvt_pk_f16_f32 v20, v20, v28
    v_cvt_pk_f16_f32 v21, v21, v29
    v_cvt_pk_f16_f32 v22, v22, v30
    v_cvt_pk_f16_f32 v23, v23, v31
    v_cvt_pk_f16_f32 v24, v24, v32
    v_cvt_pk_f16_f32 v25, v25, v33
    v_cvt_pk_f16_f32 v26, v26, v34
    v_cvt_pk_f16_f32 v27, v27, v35
    s_lshr_b32 s38, s32, 3
    s_lshl_b32 s38, s38, 4
    s_add_u32 s38, s38, s33
    s_lshl_b32 s38, s38, 8
    s_and_b32 s39, s32, 7
    s_lshl_b32 s39, s39, 5
    s_add_u32 s38, s38, s39
    s_add_u32 s38, s38, 4784128
    v_lshlrev_b32 v5, 13, v0
    buffer_store_dwordx4 v[20:23], v5, s[24:27], s38 offen
    buffer_store_dwordx4 v[24:27], v5, s[24:27], s38 offen offset:16
    s_mov_b64 exec, s[36:37]
K1_LN:
    v_cmp_gt_u32 vcc, 32, v1
    s_nop 1
    v_cndmask_b32 v70, 0, 1.0, vcc
    v_mov_b32 v71, v70
    v_lshlrev_b32 v52, 16, v10
    v_and_b32 v53, 0xffff0000, v10
    v_lshlrev_b32 v54, 16, v11
    v_and_b32 v55, 0xffff0000, v11
    v_lshlrev_b32 v56, 16, v12
    v_and_b32 v57, 0xffff0000, v12
    v_lshlrev_b32 v58, 16, v13
    v_and_b32 v59, 0xffff0000, v13
    v_lshlrev_b32 v60, 16, v14
    v_and_b32 v61, 0xffff0000, v14
    v_pk_add_f32 v[72:73], v[52:53], v[54:55]
    v_pk_add_f32 v[74:75], v[56:57], v[58:59]
    v_pk_add_f32 v[72:73], v[72:73], v[60:61]
    v_pk_add_f32 v[72:73], v[72:73], v[74:75]
    v_add_f32 v64, v72, v73
    s_nop 1
    v_add_f32_dpp v64, v64, v64 quad_perm:[1,0,3,2] row_mask:0xf bank_mask:0xf
    s_nop 1
    v_add_f32_dpp v64, v64, v64 quad_perm:[2,3,0,1] row_mask:0xf bank_mask:0xf
    s_nop 1
    v_add_f32_dpp v64, v64, v64 row_half_mirror row_mask:0xf bank_mask:0xf
    s_nop 1
    v_add_f32_dpp v64, v64, v64 row_mirror row_mask:0xf bank_mask:0xf
    v_mov_b32 v65, v64
    s_nop 1
    v_permlane16_swap_b32 v64, v65
    v_add_f32 v64, v64, v65
    v_mov_b32 v65, v64
    s_nop 1
    v_permlane32_swap_b32 v64, v65
    v_add_f32 v64, v64, v65
    v_mul_f32 v64, 0x3ae38e39, v64
    v_cvt_pk_bf16_f32 v66, v64, v64
    v_mov_b32 v65, v64
    v_lshlrev_b32 v66, 16, v66
    v_mov_b32 v67, v66
    v_pk_add_f32 v[72:73], v[52:53], v[64:65] neg_lo:[0,1] neg_hi:[0,1]
    v_pk_add_f32 v[74:75], v[54:55], v[64:65] neg_lo:[0,1] neg_hi:[0,1]
    v_pk_add_f32 v[76:77], v[56:57], v[64:65] neg_lo:[0,1] neg_hi:[0,1]
    v_pk_add_f32 v[78:79], v[58:59], v[64:65] neg_lo:[0,1] neg_hi:[0,1]
    v_pk_add_f32 v[80:81], v[60:61], v[64:65] neg_lo:[0,1] neg_hi:[0,1]
    v_pk_mul_f32 v[80:81], v[80:81], v[70:71]
    v_pk_mul_f32 v[72:73], v[72:73], v[72:73]
    v_pk_fma_f32 v[72:73], v[74:75], v[74:75], v[72:73]
    v_pk_fma_f32 v[72:73], v[76:77], v[76:77], v[72:73]
    v_pk_fma_f32 v[72:73], v[78:79], v[78:79], v[72:73]
    v_pk_fma_f32 v[72:73], v[80:81], v[80:81], v[72:73]
    v_add_f32 v68, v72, v73
    s_nop 1
    v_add_f32_dpp v68, v68, v68 quad_perm:[1,0,3,2] row_mask:0xf bank_mask:0xf
    s_nop 1
    v_add_f32_dpp v68, v68, v68 quad_perm:[2,3,0,1] row_mask:0xf bank_mask:0xf
    s_nop 1
    v_add_f32_dpp v68, v68, v68 row_half_mirror row_mask:0xf bank_mask:0xf
    s_nop 1
    v_add_f32_dpp v68, v68, v68 row_mirror row_mask:0xf bank_mask:0xf
    v_mov_b32 v69, v68
    s_nop 1
    v_permlane16_swap_b32 v68, v69
    v_add_f32 v68, v68, v69
    v_mov_b32 v69, v68
    s_nop 1
    v_permlane32_swap_b32 v68, v69
    v_add_f32 v68, v68, v69
    v_mul_f32 v68, 0x3ae38e39, v68
    v_cvt_pk_bf16_f32 v68, v68, v68
    v_lshlrev_b32 v68, 16, v68
    v_add_f32 v68, 0x3727c5ac, v68
    v_cvt_pk_bf16_f32 v68, v68, v68
    v_lshlrev_b32 v68, 16, v68
    v_sqrt_f32 v68, v68
    v_pk_add_f32 v[52:53], v[52:53], v[66:67] neg_lo:[0,1] neg_hi:[0,1]
    v_pk_add_f32 v[54:55], v[54:55], v[66:67] neg_lo:[0,1] neg_hi:[0,1]
    v_pk_add_f32 v[56:57], v[56:57], v[66:67] neg_lo:[0,1] neg_hi:[0,1]
    v_pk_add_f32 v[58:59], v[58:59], v[66:67] neg_lo:[0,1] neg_hi:[0,1]
    v_pk_add_f32 v[60:61], v[60:61], v[66:67] neg_lo:[0,1] neg_hi:[0,1]
    v_cvt_pk_bf16_f32 v68, v68, v68
    v_lshlrev_b32 v68, 16, v68
    v_rcp_f32 v68, v68
    v_cvt_pk_bf16_f32 v40, v52, v53
    v_cvt_pk_bf16_f32 v41, v54, v55
    v_cvt_pk_bf16_f32 v42, v56, v57
    v_cvt_pk_bf16_f32 v43, v58, v59
    v_cvt_pk_bf16_f32 v44, v60, v61
    v_mov_b32 v69, v68
    v_lshlrev_b32 v52, 16, v40
    v_and_b32 v53, 0xffff0000, v40
    v_lshlrev_b32 v54, 16, v41
    v_and_b32 v55, 0xffff0000, v41
    v_lshlrev_b32 v56, 16, v42
    v_and_b32 v57, 0xffff0000, v42
    v_lshlrev_b32 v58, 16, v43
    v_and_b32 v59, 0xffff0000, v43
    v_lshlrev_b32 v60, 16, v44
    v_and_b32 v61, 0xffff0000, v44
    v_pk_mul_f32 v[52:53], v[52:53], v[68:69]
    v_pk_mul_f32 v[54:55], v[54:55], v[68:69]
    v_pk_mul_f32 v[56:57], v[56:57], v[68:69]
    v_pk_mul_f32 v[58:59], v[58:59], v[68:69]
    v_pk_mul_f32 v[60:61], v[60:61], v[68:69]
    v_pk_mul_f32 v[60:61], v[60:61], v[70:71]
    v_cvt_pk_bf16_f32 v40, v52, v53
    v_cvt_pk_bf16_f32 v41, v54, v55
    v_cvt_pk_bf16_f32 v42, v56, v57
    v_cvt_pk_bf16_f32 v43, v58, v59
    v_cvt_pk_bf16_f32 v44, v60, v61
    v_lshlrev_b32 v52, 16, v40
    v_and_b32 v53, 0xffff0000, v40
    v_lshlrev_b32 v54, 16, v41
    v_and_b32 v55, 0xffff0000, v41
    v_lshlrev_b32 v56, 16, v42
    v_and_b32 v57, 0xffff0000, v42
    v_lshlrev_b32 v58, 16, v43
    v_and_b32 v59, 0xffff0000, v43
    v_lshlrev_b32 v60, 16, v44
    v_and_b32 v61, 0xffff0000, v44
    v_cvt_pk_f16_f32 v84, v52, v54
    v_cvt_pk_f16_f32 v85, v56, v58
    v_cvt_pk_f16_f32 v86, v60, 0
    v_cvt_pk_f16_f32 v88, v53, v55
    v_cvt_pk_f16_f32 v89, v57, v59
    v_cvt_pk_f16_f32 v90, v61, 0
    s_lshl_b32 s38, s3, 2
    v_and_b32 v4, 1, v1
    v_lshlrev_b32 v4, 1, v4
    v_add_u32 v4, s38, v4
    v_mul_u32_u24 v4, 336, v4
    v_lshrrev_b32 v5, 1, v1
    v_lshl_add_u32 v6, v5, 2, v4
    v_lshl_add_u32 v4, v5, 3, v4
    ds_write_b64 v4, v[84:85] offset:0
    ds_write_b64 v4, v[88:89] offset:336
    s_mov_b64 exec, 0xffffffff
    ds_write_b32 v6, v86 offset:256
    ds_write_b32 v6, v90 offset:592
    s_mov_b64 exec, -1
    s_waitcnt lgkmcnt(0)
    s_barrier
    v_lshlrev_b32 v52, 16, v40
    v_and_b32 v53, 0xffff0000, v40
    v_lshlrev_b32 v54, 16, v41
    v_and_b32 v55, 0xffff0000, v41
    v_lshlrev_b32 v56, 16, v42
    v_and_b32 v57, 0xffff0000, v42
    v_lshlrev_b32 v58, 16, v43
    v_and_b32 v59, 0xffff0000, v43
    v_lshlrev_b32 v60, 16, v44
    v_and_b32 v61, 0xffff0000, v44
    v_pk_add_f32 v[72:73], v[52:53], v[54:55]
    v_pk_add_f32 v[74:75], v[56:57], v[58:59]
    v_pk_add_f32 v[72:73], v[72:73], v[60:61]
    v_pk_add_f32 v[72:73], v[72:73], v[74:75]
    v_add_f32 v64, v72, v73
    s_nop 1
    v_add_f32_dpp v64, v64, v64 quad_perm:[1,0,3,2] row_mask:0xf bank_mask:0xf
    s_nop 1
    v_add_f32_dpp v64, v64, v64 quad_perm:[2,3,0,1] row_mask:0xf bank_mask:0xf
    s_nop 1
    v_add_f32_dpp v64, v64, v64 row_half_mirror row_mask:0xf bank_mask:0xf
    s_nop 1
    v_add_f32_dpp v64, v64, v64 row_mirror row_mask:0xf bank_mask:0xf
    v_mov_b32 v65, v64
    s_nop 1
    v_permlane16_swap_b32 v64, v65
    v_add_f32 v64, v64, v65
    v_mov_b32 v65, v64
    s_nop 1
    v_permlane32_swap_b32 v64, v65
    v_add_f32 v64, v64, v65
    v_mul_f32 v64, 0x3ae38e39, v64
    v_cvt_pk_bf16_f32 v66, v64, v64
    v_mov_b32 v65, v64
    v_lshlrev_b32 v66, 16, v66
    v_mov_b32 v67, v66
    v_pk_add_f32 v[72:73], v[52:53], v[64:65] neg_lo:[0,1] neg_hi:[0,1]
    v_pk_add_f32 v[74:75], v[54:55], v[64:65] neg_lo:[0,1] neg_hi:[0,1]
    v_pk_add_f32 v[76:77], v[56:57], v[64:65] neg_lo:[0,1] neg_hi:[0,1]
    v_pk_add_f32 v[78:79], v[58:59], v[64:65] neg_lo:[0,1] neg_hi:[0,1]
    v_pk_add_f32 v[80:81], v[60:61], v[64:65] neg_lo:[0,1] neg_hi:[0,1]
    v_pk_mul_f32 v[80:81], v[80:81], v[70:71]
    v_pk_mul_f32 v[72:73], v[72:73], v[72:73]
    v_pk_fma_f32 v[72:73], v[74:75], v[74:75], v[72:73]
    v_pk_fma_f32 v[72:73], v[76:77], v[76:77], v[72:73]
    v_pk_fma_f32 v[72:73], v[78:79], v[78:79], v[72:73]
    v_pk_fma_f32 v[72:73], v[80:81], v[80:81], v[72:73]
    v_add_f32 v68, v72, v73
    s_nop 1
    v_add_f32_dpp v68, v68, v68 quad_perm:[1,0,3,2] row_mask:0xf bank_mask:0xf
    s_nop 1
    v_add_f32_dpp v68, v68, v68 quad_perm:[2,3,0,1] row_mask:0xf bank_mask:0xf
    s_nop 1
    v_add_f32_dpp v68, v68, v68 row_half_mirror row_mask:0xf bank_mask:0xf
    s_nop 1
    v_add_f32_dpp v68, v68, v68 row_mirror row_mask:0xf bank_mask:0xf
    v_mov_b32 v69, v68
    s_nop 1
    v_permlane16_swap_b32 v68, v69
    v_add_f32 v68, v68, v69
    v_mov_b32 v69, v68
    s_nop 1
    v_permlane32_swap_b32 v68, v69
    v_add_f32 v68, v68, v69
    v_mul_f32 v68, 0x3ae38e39, v68
    v_cvt_pk_bf16_f32 v68, v68, v68
    v_lshlrev_b32 v68, 16, v68
    v_add_f32 v68, 0x3727c5ac, v68
    v_cvt_pk_bf16_f32 v68, v68, v68
    v_lshlrev_b32 v68, 16, v68
    v_sqrt_f32 v68, v68
    v_pk_add_f32 v[52:53], v[52:53], v[66:67] neg_lo:[0,1] neg_hi:[0,1]
    v_pk_add_f32 v[54:55], v[54:55], v[66:67] neg_lo:[0,1] neg_hi:[0,1]
    v_pk_add_f32 v[56:57], v[56:57], v[66:67] neg_lo:[0,1] neg_hi:[0,1]
    v_pk_add_f32 v[58:59], v[58:59], v[66:67] neg_lo:[0,1] neg_hi:[0,1]
    v_pk_add_f32 v[60:61], v[60:61], v[66:67] neg_lo:[0,1] neg_hi:[0,1]
    v_cvt_pk_bf16_f32 v68, v68, v68
    v_lshlrev_b32 v68, 16, v68
    v_rcp_f32 v68, v68
    v_cvt_pk_bf16_f32 v46, v52, v53
    v_cvt_pk_bf16_f32 v47, v54, v55
    v_cvt_pk_bf16_f32 v48, v56, v57
    v_cvt_pk_bf16_f32 v49, v58, v59
    v_cvt_pk_bf16_f32 v50, v60, v61
    v_mov_b32 v69, v68
    v_lshlrev_b32 v52, 16, v46
    v_and_b32 v53, 0xffff0000, v46
    v_lshlrev_b32 v54, 16, v47
    v_and_b32 v55, 0xffff0000, v47
    v_lshlrev_b32 v56, 16, v48
    v_and_b32 v57, 0xffff0000, v48
    v_lshlrev_b32 v58, 16, v49
    v_and_b32 v59, 0xffff0000, v49
    v_lshlrev_b32 v60, 16, v50
    v_and_b32 v61, 0xffff0000, v50
    v_pk_mul_f32 v[52:53], v[52:53], v[68:69]
    v_pk_mul_f32 v[54:55], v[54:55], v[68:69]
    v_pk_mul_f32 v[56:57], v[56:57], v[68:69]
    v_pk_mul_f32 v[58:59], v[58:59], v[68:69]
    v_pk_mul_f32 v[60:61], v[60:61], v[68:69]
    v_pk_mul_f32 v[60:61], v[60:61], v[70:71]
    v_cvt_pk_bf16_f32 v46, v52, v53
    v_cvt_pk_bf16_f32 v47, v54, v55
    v_cvt_pk_bf16_f32 v48, v56, v57
    v_cvt_pk_bf16_f32 v49, v58, v59
    v_cvt_pk_bf16_f32 v50, v60, v61
    v_add_u32 v4, 0, v1
    v_mul_u32_u24 v5, 1366, v4
    v_lshrrev_b32 v5, 16, v5
    v_mul_u32_u24 v6, 48, v5
    v_sub_u32 v6, v4, v6
    v_mul_u32_u24 v5, 393216, v5
    v_lshl_add_u32 v5, v6, 2, v5
    buffer_store_dword v46, v5, s[24:27], s43 offen
    v_add_u32 v4, 64, v1
    v_mul_u32_u24 v5, 1366, v4
    v_lshrrev_b32 v5, 16, v5
    v_mul_u32_u24 v6, 48, v5
    v_sub_u32 v6, v4, v6
    v_mul_u32_u24 v5, 393216, v5
    v_lshl_add_u32 v5, v6, 2, v5
    buffer_store_dword v47, v5, s[24:27], s43 offen
    v_add_u32 v4, 128, v1
    v_mul_u32_u24 v5, 1366, v4
    v_lshrrev_b32 v5, 16, v5
    v_mul_u32_u24 v6, 48, v5
    v_sub_u32 v6, v4, v6
    v_mul_u32_u24 v5, 393216, v5
    v_lshl_add_u32 v5, v6, 2, v5
    buffer_store_dword v48, v5, s[24:27], s43 offen
    v_add_u32 v4, 192, v1
    v_mul_u32_u24 v5, 1366, v4
    v_lshrrev_b32 v5, 16, v5
    v_mul_u32_u24 v6, 48, v5
    v_sub_u32 v6, v4, v6
    v_mul_u32_u24 v5, 393216, v5
    v_lshl_add_u32 v5, v6, 2, v5
    buffer_store_dword v49, v5, s[24:27], s43 offen
    v_add_u32 v4, 256, v1
    v_mul_u32_u24 v5, 1366, v4
    v_lshrrev_b32 v5, 16, v5
    v_mul_u32_u24 v6, 48, v5
    v_sub_u32 v6, v4, v6
    v_mul_u32_u24 v5, 393216, v5
    v_lshl_add_u32 v5, v6, 2, v5
    s_mov_b64 exec, 0xffffffff
    buffer_store_dword v50, v5, s[24:27], s43 offen
    s_mov_b64 exec, -1
    s_endpgm
K1_NOLN:
    s_and_b32 s46, s2, 7
    s_mul_i32 s47, s46, 1280
    s_mul_i32 s52, s46, 1024
    s_add_u32 s52, s52, 1024
    s_cmp_lt_u32 s46, 4
    s_cselect_b32 s53, 20, 16
    s_cselect_b32 s46, s47, s52
    s_lshr_b32 s47, s2, 3
    s_mul_i32 s47, s47, 589824
    s_add_u32 s46, s46, s47
    v_subrev_u32 v6, 512, v0
    v_mul_u32_u24 v7, 3277, v6
    v_lshrrev_b32 v7, 16, v7
    v_mul_u32_u24 v8, 20, v7
    v_sub_u32 v8, v6, v8
    v_mul_u32_u24 v7, 9216, v7
    v_lshl_add_u32 v6, v8, 6, v7
    v_cmp_gt_u32 vcc, s53, v8
    s_nop 3
    s_and_b64 exec, exec, vcc
    buffer_load_dword v124, v6, s[48:51], s46 offen
    s_add_u32 s46, s46, 147456
    buffer_load_dword v125, v6, s[48:51], s46 offen
    s_add_u32 s46, s46, 147456
    buffer_load_dword v126, v6, s[48:51], s46 offen
    s_add_u32 s46, s46, 147456
    buffer_load_dword v127, v6, s[48:51], s46 offen
    s_add_u32 s46, s46, 147456
    s_mov_b64 exec, -1
    s_barrier
    v_and_b32 v6, 15, v1
    v_lshrrev_b32 v7, 4, v1
    v_mul_u32_u24 v4, 336, v6
    v_lshl_add_u32 v4, v7, 4, v4
    ds_read_b128 v[104:107], v4 offset:0
    ds_read_b128 v[108:111], v4 offset:64
    ds_read_b128 v[112:115], v4 offset:128
    ds_read_b128 v[116:119], v4 offset:192
    ds_read_b128 v[120:123], v4 offset:256
    s_sub_u32 s35, s3, 8
    s_lshl_b32 s35, s35, 4
    v_add_u32 v8, s35, v6
    v_lshlrev_b32 v9, 13, v8
    v_lshl_add_u32 v10, v7, 2, v9
    v_lshlrev_b32 v11, 2, v7
    v_sub_u32 v11, v11, v9
    v_add_u32 v11, 2359296, v11
    s_lshl_b32 s40, s28, 10
    s_lshl_b32 s39, s29, 5
    s_add_u32 s38, s40, s39
    s_add_u32 s38, s38, 2359296
    s_add_u32 s39, s38, 1179648
    s_sub_u32 s40, s38, 1179648
    s_waitcnt lgkmcnt(0)
    v_mfma_f32_16x16x32_f16 v[88:91], v[104:107], v[40:43], 0
    v_mfma_f32_16x16x32_f16 v[92:95], v[104:107], v[60:63], 0
    v_mfma_f32_16x16x32_f16 v[88:91], v[108:111], v[44:47], v[88:91]
    v_mfma_f32_16x16x32_f16 v[92:95], v[108:111], v[64:67], v[92:95]
    v_mfma_f32_16x16x32_f16 v[88:91], v[112:115], v[48:51], v[88:91]
    v_mfma_f32_16x16x32_f16 v[92:95], v[112:115], v[68:71], v[92:95]
    v_mfma_f32_16x16x32_f16 v[88:91], v[116:119], v[52:55], v[88:91]
    v_mfma_f32_16x16x32_f16 v[92:95], v[116:119], v[72:75], v[92:95]
    v_mfma_f32_16x16x32_f16 v[88:91], v[120:123], v[56:59], v[88:91]
    v_mfma_f32_16x16x32_f16 v[92:95], v[120:123], v[76:79], v[92:95]
    ds_read_b128 v[12:15], v4 offset:5376
    ds_read_b128 v[16:19], v4 offset:5440
    ds_read_b128 v[20:23], v4 offset:5504
    ds_read_b128 v[24:27], v4 offset:5568
    ds_read_b128 v[28:31], v4 offset:5632
    s_waitcnt lgkmcnt(0)
    v_mfma_f32_16x16x32_f16 v[96:99], v[12:15], v[40:43], 0
    v_mfma_f32_16x16x32_f16 v[100:103], v[12:15], v[60:63], 0
    v_mfma_f32_16x16x32_f16 v[96:99], v[16:19], v[44:47], v[96:99]
    v_mfma_f32_16x16x32_f16 v[100:103], v[16:19], v[64:67], v[100:103]
    v_mfma_f32_16x16x32_f16 v[96:99], v[20:23], v[48:51], v[96:99]
    v_mfma_f32_16x16x32_f16 v[100:103], v[20:23], v[68:71], v[100:103]
    v_mfma_f32_16x16x32_f16 v[96:99], v[24:27], v[52:55], v[96:99]
    v_mfma_f32_16x16x32_f16 v[100:103], v[24:27], v[72:75], v[100:103]
    v_mfma_f32_16x16x32_f16 v[96:99], v[28:31], v[56:59], v[96:99]
    v_mfma_f32_16x16x32_f16 v[100:103], v[28:31], v[76:79], v[100:103]
    v_cmp_gt_u32 vcc, 73, v8
    s_nop 3
    s_and_saveexec_b64 s[36:37], vcc
    v_mul_f32 v106, v89, v80
    v_fma_f32 v106, -v93, v81, v106
    v_mul_f32 v107, v89, v81
    v_fmac_f32 v107, v93, v80
    v_mul_f32 v108, v90, v82
    v_fma_f32 v108, -v94, v83, v108
    v_mul_f32 v109, v90, v83
    v_fmac_f32 v109, v94, v82
    v_mul_f32 v110, v91, v84
    v_fma_f32 v110, -v95, v85, v110
    v_mul_f32 v111, v91, v85
    v_fmac_f32 v111, v95, v84
    v_add_f32 v112, v88, v108
    v_add_f32 v113, v92, v109
    v_sub_f32 v114, v88, v108
    v_sub_f32 v115, v92, v109
    v_add_f32 v116, v106, v110
    v_add_f32 v117, v107, v111
    v_sub_f32 v118, v106, v110
    v_sub_f32 v119, v107, v111
    v_add_f32 v104, v114, v119
    v_sub_f32 v105, v115, v118
    v_cvt_pk_f16_f32 v35, v104, v105
    v_sub_f32 v106, v112, v116
    v_sub_f32 v107, v113, v117
    buffer_store_dword v35, v11, s[24:27], s40 offen offset:0
    v_cvt_pk_f16_f32 v33, v106, v107
    v_sub_f32 v104, v114, v119
    v_add_f32 v105, v115, v118
    buffer_store_dword v33, v11, s[24:27], s38 offen offset:0
    v_cvt_pk_f16_f32 v34, v104, -v105
    v_add_f32 v106, v112, v116
    v_add_f32 v107, v113, v117
    buffer_store_dword v34, v10, s[24:27], s39 offen offset:0
    v_cvt_pk_f16_f32 v32, v106, -v107
    buffer_store_dword v32, v10, s[24:27], s38 offen offset:0
    v_mul_f32 v106, v97, v80
    v_fma_f32 v106, -v101, v81, v106
    v_mul_f32 v107, v97, v81
    v_fmac_f32 v107, v101, v80
    v_mul_f32 v108, v98, v82
    v_fma_f32 v108, -v102, v83, v108
    v_mul_f32 v109, v98, v83
    v_fmac_f32 v109, v102, v82
    v_mul_f32 v110, v99, v84
    v_fma_f32 v110, -v103, v85, v110
    v_mul_f32 v111, v99, v85
    v_fmac_f32 v111, v103, v84
    v_add_f32 v112, v96, v108
    v_add_f32 v113, v100, v109
    v_sub_f32 v114, v96, v108
    v_sub_f32 v115, v100, v109
    v_add_f32 v116, v106, v110
    v_add_f32 v117, v107, v111
    v_sub_f32 v118, v106, v110
    v_sub_f32 v119, v107, v111
    v_add_f32 v104, v114, v119
    v_sub_f32 v105, v115, v118
    v_cvt_pk_f16_f32 v39, v104, v105
    v_sub_f32 v106, v112, v116
    v_sub_f32 v107, v113, v117
    buffer_store_dword v39, v11, s[24:27], s40 offen offset:16
    v_cvt_pk_f16_f32 v37, v106, v107
    v_sub_f32 v104, v114, v119
    v_add_f32 v105, v115, v118
    buffer_store_dword v37, v11, s[24:27], s38 offen offset:16
    v_cvt_pk_f16_f32 v38, v104, -v105
    v_add_f32 v106, v112, v116
    v_add_f32 v107, v113, v117
    buffer_store_dword v38, v10, s[24:27], s39 offen offset:16
    v_cvt_pk_f16_f32 v36, v106, -v107
    buffer_store_dword v36, v10, s[24:27], s38 offen offset:16
K1_END:
    s_endpgm

.globl k2_kernel
.p2align 8
.type k2_kernel,@function
k2_kernel:
    s_cmp_ge_u32 s2, 256
    s_cbranch_scc1 K2_END
    s_load_dwordx4 s[4:7], s[0:1], 32
    s_load_dwordx2 s[8:9], s[0:1], 80
    v_and_b32 v1, 63, v0
    v_lshrrev_b32 v2, 6, v0
    s_nop 0
    v_readfirstlane_b32 s3, v2
    s_waitcnt lgkmcnt(0)
    s_mov_b32 s12, s4
    s_mov_b32 s13, s5
    s_mov_b32 s14, 18874368
    s_mov_b32 s15, 0x00020000
    s_mov_b32 s16, s8
    s_mov_b32 s17, s9
    s_mov_b32 s18, 2359296
    s_mov_b32 s19, 0x00020000
    s_mov_b32 s20, s6
    s_mov_b32 s21, s7
    s_mov_b32 s22, 9216
    s_mov_b32 s23, 0x00020000
    s_mov_b32 s24, s8
    s_mov_b32 s25, s9
    s_mov_b32 s26, 15728640
    s_mov_b32 s27, 0x00020000
    s_and_b32 s28, s2, 7
    s_lshr_b32 s29, s2, 3
    s_cmp_lt_u32 s28, 4
    s_cselect_b32 s30, 30, 24
    s_cmp_ge_u32 s29, s30
    s_cbranch_scc1 K2_FFT
    s_mul_i32 s30, s29, 10923
    s_lshr_b32 s30, s30, 16
    s_mul_i32 s31, s30, 6
    s_sub_u32 s31, s29, s31
    s_mul_i32 s32, s28, 5
    s_lshl_b32 s33, s28, 2
    s_add_u32 s33, s33, 4
    s_cmp_lt_u32 s28, 4
    s_cselect_b32 s29, s32, s33
    s_add_u32 s29, s29, s30
    s_mov_b32 s30, s31
    s_lshl_b32 s31, s29, 8
    s_mul_i32 s32, s30, 192
    s_cmp_lt_u32 s3, 4
    s_cbranch_scc1 G1_CONS
    s_sub_u32 s3, s3, 4
    v_lshrrev_b32 v10, 4, v1
    v_and_b32 v11, 15, v1
    v_lshlrev_b32 v12, 2, v10
    v_xor_b32 v11, v11, v12
    v_mul_u32_u24 v2, 9216, v10
    v_lshl_add_u32 v2, v11, 4, v2
    v_add_u32 v3, 35840, v2
    v_lshlrev_b32 v4, 4, v1
    v_mov_b32 v5, v4
    s_mul_i32 s33, s3, 73728
    s_add_u32 s33, s33, s31
    s_mul_i32 s34, s3, 1536
    s_mul_i32 s32, s30, 393216
    s_add_u32 s34, s34, s32
    s_lshl_b32 s35, s3, 11
    s_mul_i32 s36, s3, 1536
    s_add_u32 s36, s36, 8192
    s_mov_b32 s37, 0
    s_add_u32 s38, s37, s35
    s_mov_b32 m0, s38
    s_add_u32 s38, s37, s36
    buffer_load_dwordx4 v2, s[12:15], s33 offen offset:0 lds
    buffer_load_dwordx4 v3, s[12:15], s33 offen offset:1024 lds
    s_mov_b32 m0, s38
    s_add_u32 s33, s33, 294912
    buffer_load_dwordx4 v4, s[16:19], s34 offen lds
    s_mov_b64 exec, 0xffffffff
    buffer_load_dwordx4 v5, s[16:19], s34 offen offset:1024 lds
    s_mov_b64 exec, -1
    s_add_u32 s34, s34, 6144
    s_add_u32 s37, s37, 14336
    s_cmp_ge_u32 s37, 157696
    s_cselect_b32 s37, 0, s37
    s_add_u32 s38, s37, s35
    s_mov_b32 m0, s38
    s_add_u32 s38, s37, s36
    buffer_load_dwordx4 v2, s[12:15], s33 offen offset:0 lds
    buffer_load_dwordx4 v3, s[12:15], s33 offen offset:1024 lds
    s_mov_b32 m0, s38
    s_add_u32 s33, s33, 294912
    buffer_load_dwordx4 v4, s[16:19], s34 offen lds
    s_mov_b64 exec, 0xffffffff
    buffer_load_dwordx4 v5, s[16:19], s34 offen offset:1024 lds
    s_mov_b64 exec, -1
    s_add_u32 s34, s34, 6144
    s_add_u32 s37, s37, 14336
    s_cmp_ge_u32 s37, 157696
    s_cselect_b32 s37, 0, s37
    s_add_u32 s38, s37, s35
    s_mov_b32 m0, s38
    s_add_u32 s38, s37, s36
    buffer_load_dwordx4 v2, s[12:15], s33 offen offset:0 lds
    buffer_load_dwordx4 v3, s[12:15], s33 offen offset:1024 lds
    s_mov_b32 m0, s38
    s_add_u32 s33, s33, 294912
    buffer_load_dwordx4 v4, s[16:19], s34 offen lds
    s_mov_b64 exec, 0xffffffff
    buffer_load_dwordx4 v5, s[16:19], s34 offen offset:1024 lds
    s_mov_b64 exec, -1
    s_add_u32 s34, s34, 6144
    s_add_u32 s37, s37, 14336
    s_cmp_ge_u32 s37, 157696
    s_cselect_b32 s37, 0, s37
    s_add_u32 s38, s37, s35
    s_mov_b32 m0, s38
    s_add_u32 s38, s37, s36
    buffer_load_dwordx4 v2, s[12:15], s33 offen offset:0 lds
    buffer_load_dwordx4 v3, s[12:15], s33 offen offset:1024 lds
    s_mov_b32 m0, s38
    s_add_u32 s33, s33, 294912
    buffer_load_dwordx4 v4, s[16:19], s34 offen lds
    s_mov_b64 exec, 0xffffffff
    buffer_load_dwordx4 v5, s[16:19], s34 offen offset:1024 lds
    s_mov_b64 exec, -1
    s_add_u32 s34, s34, 6144
    s_add_u32 s37, s37, 14336
    s_cmp_ge_u32 s37, 157696
    s_cselect_b32 s37, 0, s37
    s_add_u32 s38, s37, s35
    s_mov_b32 m0, s38
    s_add_u32 s38, s37, s36
    buffer_load_dwordx4 v2, s[12:15], s33 offen offset:0 lds
    buffer_load_dwordx4 v3, s[12:15], s33 offen offset:1024 lds
    s_mov_b32 m0, s38
    s_add_u32 s33, s33, 294912
    buffer_load_dwordx4 v4, s[16:19], s34 offen lds
    s_mov_b64 exec, 0xffffffff
    buffer_load_dwordx4 v5, s[16:19], s34 offen offset:1024 lds
    s_mov_b64 exec, -1
    s_add_u32 s34, s34, 6144
    s_add_u32 s37, s37, 14336
    s_cmp_ge_u32 s37, 157696
    s_cselect_b32 s37, 0, s37
    s_add_u32 s38, s37, s35
    s_mov_b32 m0, s38
    s_add_u32 s38, s37, s36
    buffer_load_dwordx4 v2, s[12:15], s33 offen offset:0 lds
    buffer_load_dwordx4 v3, s[12:15], s33 offen offset:1024 lds
    s_mov_b32 m0, s38
    s_add_u32 s33, s33, 294912
    buffer_load_dwordx4 v4, s[16:19], s34 offen lds
    s_mov_b64 exec, 0xffffffff
    buffer_load_dwordx4 v5, s[16:19], s34 offen offset:1024 lds
    s_mov_b64 exec, -1
    s_add_u32 s34, s34, 6144
    s_add_u32 s37, s37, 14336
    s_cmp_ge_u32 s37, 157696
    s_cselect_b32 s37, 0, s37
    s_add_u32 s38, s37, s35
    s_mov_b32 m0, s38
    s_add_u32 s38, s37, s36
    buffer_load_dwordx4 v2, s[12:15], s33 offen offset:0 lds
    buffer_load_dwordx4 v3, s[12:15], s33 offen offset:1024 lds
    s_mov_b32 m0, s38
    s_add_u32 s33, s33, 294912
    buffer_load_dwordx4 v4, s[16:19], s34 offen lds
    s_mov_b64 exec, 0xffffffff
    buffer_load_dwordx4 v5, s[16:19], s34 offen offset:1024 lds
    s_mov_b64 exec, -1
    s_add_u32 s34, s34, 6144
    s_add_u32 s37, s37, 14336
    s_cmp_ge_u32 s37, 157696
    s_cselect_b32 s37, 0, s37
    s_add_u32 s38, s37, s35
    s_mov_b32 m0, s38
    s_add_u32 s38, s37, s36
    buffer_load_dwordx4 v2, s[12:15], s33 offen offset:0 lds
    buffer_load_dwordx4 v3, s[12:15], s33 offen offset:1024 lds
    s_mov_b32 m0, s38
    s_add_u32 s33, s33, 294912
    buffer_load_dwordx4 v4, s[16:19], s34 offen lds
    s_mov_b64 exec, 0xffffffff
    buffer_load_dwordx4 v5, s[16:19], s34 offen offset:1024 lds
    s_mov_b64 exec, -1
    s_add_u32 s34, s34, 6144
    s_add_u32 s37, s37, 14336
    s_cmp_ge_u32 s37, 157696
    s_cselect_b32 s37, 0, s37
    s_add_u32 s38, s37, s35
    s_mov_b32 m0, s38
    s_add_u32 s38, s37, s36
    buffer_load_dwordx4 v2, s[12:15], s33 offen offset:0 lds
    buffer_load_dwordx4 v3, s[12:15], s33 offen offset:1024 lds
    s_mov_b32 m0, s38
    s_add_u32 s33, s33, 294912
    buffer_load_dwordx4 v4, s[16:19], s34 offen lds
    s_mov_b64 exec, 0xffffffff
    buffer_load_dwordx4 v5, s[16:19], s34 offen offset:1024 lds
    s_mov_b64 exec, -1
    s_add_u32 s34, s34, 6144
    s_add_u32 s37, s37, 14336
    s_cmp_ge_u32 s37, 157696
    s_cselect_b32 s37, 0, s37
    s_add_u32 s38, s37, s35
    s_mov_b32 m0, s38
    s_add_u32 s38, s37, s36
    buffer_load_dwordx4 v2, s[12:15], s33 offen offset:0 lds
    buffer_load_dwordx4 v3, s[12:15], s33 offen offset:1024 lds
    s_mov_b32 m0, s38
    s_add_u32 s33, s33, 294912
    buffer_load_dwordx4 v4, s[16:19], s34 offen lds
    s_mov_b64 exec, 0xffffffff
    buffer_load_dwordx4 v5, s[16:19], s34 offen offset:1024 lds
    s_mov_b64 exec, -1
    s_add_u32 s34, s34, 6144
    s_add_u32 s37, s37, 14336
    s_cmp_ge_u32 s37, 157696
    s_cselect_b32 s37, 0, s37
    s_waitcnt vmcnt(32)
    s_barrier
    s_mov_b32 s44, 0
G1_LLOOP:
    s_waitcnt vmcnt(28)
    s_barrier
    s_add_u32 s38, s37, s35
    s_mov_b32 m0, s38
    s_add_u32 s38, s37, s36
    buffer_load_dwordx4 v2, s[12:15], s33 offen offset:0 lds
    buffer_load_dwordx4 v3, s[12:15], s33 offen offset:1024 lds
    s_mov_b32 m0, s38
    s_add_u32 s33, s33, 294912
    buffer_load_dwordx4 v4, s[16:19], s34 offen lds
    s_mov_b64 exec, 0xffffffff
    buffer_load_dwordx4 v5, s[16:19], s34 offen offset:1024 lds
    s_mov_b64 exec, -1
    s_add_u32 s34, s34, 6144
    s_add_u32 s37, s37, 14336
    s_cmp_ge_u32 s37, 157696
    s_cselect_b32 s37, 0, s37
    s_add_u32 s44, s44, 1
    s_cmp_lt_u32 s44, 54
    s_cbranch_scc1 G1_LLOOP
    s_waitcnt vmcnt(28)
    s_barrier
    s_waitcnt vmcnt(24)
    s_barrier
    s_waitcnt vmcnt(20)
    s_barrier
    s_waitcnt vmcnt(16)
    s_barrier
    s_waitcnt vmcnt(12)
    s_barrier
    s_waitcnt vmcnt(8)
    s_barrier
    s_waitcnt vmcnt(4)
    s_barrier
    s_waitcnt vmcnt(0)
    s_barrier
    s_waitcnt vmcnt(0)
    s_barrier
    s_waitcnt vmcnt(0)
    s_barrier
    s_waitcnt vmcnt(0)
    s_barrier
    s_add_u32 s3, s3, 4
    s_branch G1_EPI
G1_CONS:
    s_and_b32 s40, s3, 1
    s_lshr_b32 s41, s3, 1
    v_lshrrev_b32 v10, 5, v1
    v_bfe_u32 v11, v1, 2, 2
    v_lshl_add_u32 v10, v10, 3, v11
    s_lshl_b32 s42, s40, 4
    v_add_u32 v10, s42, v10
    v_bfe_u32 v12, v1, 4, 1
    v_bfe_u32 v13, v1, 1, 1
    v_lshl_add_u32 v12, v12, 1, v13
    v_and_b32 v13, 1, v1
    v_lshlrev_b32 v13, 3, v13
    v_lshl_add_u32 v13, v12, 4, v13
    s_lshl_b32 s42, s41, 1
    v_xor_b32 v14, s42, v11
    v_lshlrev_b32 v2, 8, v10
    v_lshl_add_u32 v2, v14, 6, v2
    v_add_u32 v2, v2, v13
    v_xor_b32 v3, 64, v2
    v_mul_u32_u24 v4, 192, v10
    v_add_u32 v4, v4, v13
    v_add_u32 v4, 8192, v4
    v_mov_b32 v16, 0
    v_mov_b32 v17, 0
    v_mov_b32 v18, 0
    v_mov_b32 v19, 0
    v_mov_b32 v20, 0
    v_mov_b32 v21, 0
    v_mov_b32 v22, 0
    v_mov_b32 v23, 0
    v_mov_b32 v24, 0
    v_mov_b32 v25, 0
    v_mov_b32 v26, 0
    v_mov_b32 v27, 0
    v_mov_b32 v28, 0
    v_mov_b32 v29, 0
    v_mov_b32 v30, 0
    v_mov_b32 v31, 0
    v_mov_b32 v32, 0
    v_mov_b32 v33, 0
    v_mov_b32 v34, 0
    v_mov_b32 v35, 0
    v_mov_b32 v36, 0
    v_mov_b32 v37, 0
    v_mov_b32 v38, 0
    v_mov_b32 v39, 0
    v_mov_b32 v40, 0
    v_mov_b32 v41, 0
    v_mov_b32 v42, 0
    v_mov_b32 v43, 0
    v_mov_b32 v44, 0
    v_mov_b32 v45, 0
    v_mov_b32 v46, 0
    v_mov_b32 v47, 0
    v_mov_b32 v48, 0
    v_mov_b32 v49, 0
    v_mov_b32 v50, 0
    v_mov_b32 v51, 0
    v_mov_b32 v52, 0
    v_mov_b32 v53, 0
    v_mov_b32 v54, 0
    v_mov_b32 v55, 0
    v_mov_b32 v56, 0
    v_mov_b32 v57, 0
    v_mov_b32 v58, 0
    v_mov_b32 v59, 0
    v_mov_b32 v60, 0
    v_mov_b32 v61, 0
    v_mov_b32 v62, 0
    v_mov_b32 v63, 0
    v_mov_b32 v64, 0
    v_mov_b32 v65, 0
    v_mov_b32 v66, 0
    v_mov_b32 v67, 0
    v_mov_b32 v68, 0
    v_mov_b32 v69, 0
    v_mov_b32 v70, 0
    v_mov_b32 v71, 0
    v_mov_b32 v72, 0
    v_mov_b32 v73, 0
    v_mov_b32 v74, 0
    v_mov_b32 v75, 0
    v_mov_b32 v76, 0
    v_mov_b32 v77, 0
    v_mov_b32 v78, 0
    v_mov_b32 v79, 0
    v_mov_b32 v80, 0
    v_mov_b32 v81, 0
    v_mov_b32 v82, 0
    v_mov_b32 v83, 0
    v_mov_b32 v84, 0
    v_mov_b32 v85, 0
    v_mov_b32 v86, 0
    v_mov_b32 v87, 0
    v_mov_b32 v88, 0
    v_mov_b32 v89, 0
    v_mov_b32 v90, 0
    v_mov_b32 v91, 0
    v_mov_b32 v92, 0
    v_mov_b32 v93, 0
    v_mov_b32 v94, 0
    v_mov_b32 v95, 0
    v_mov_b32 v96, 0
    v_mov_b32 v97, 0
    v_mov_b32 v98, 0
    v_mov_b32 v99, 0
    v_mov_b32 v100, 0
    v_mov_b32 v101, 0
    v_mov_b32 v102, 0
    v_mov_b32 v103, 0
    v_mov_b32 v104, 0
    v_mov_b32 v105, 0
    v_mov_b32 v106, 0
    v_mov_b32 v107, 0
    v_mov_b32 v108, 0
    v_mov_b32 v109, 0
    v_mov_b32 v110, 0
    v_mov_b32 v111, 0
    s_barrier
    s_mov_b32 s43, 0
    v_add_u32 v5, s43, v2
    v_add_u32 v6, s43, v3
    v_add_u32 v7, s43, v4
    ds_read_b64_tr_b16 v[112:113], v5
    ds_read_b64_tr_b16 v[114:115], v5 offset:1024
    ds_read_b64_tr_b16 v[116:117], v6
    ds_read_b64_tr_b16 v[118:119], v6 offset:1024
    ds_read_b64_tr_b16 v[120:121], v7 offset:0
    ds_read_b64_tr_b16 v[122:123], v7 offset:768
    ds_read_b64_tr_b16 v[124:125], v7 offset:64
    ds_read_b64_tr_b16 v[126:127], v7 offset:832
    ds_read_b64_tr_b16 v[128:129], v7 offset:128
    ds_read_b64_tr_b16 v[130:131], v7 offset:896
    s_add_u32 s43, s43, 14336
    s_cmp_ge_u32 s43, 157696
    s_cselect_b32 s43, 0, s43
    v_add_u32 v5, s43, v2
    v_add_u32 v6, s43, v3
    v_add_u32 v7, s43, v4
    ds_read_b64_tr_b16 v[132:133], v5
    ds_read_b64_tr_b16 v[134:135], v5 offset:1024
    ds_read_b64_tr_b16 v[136:137], v6
    ds_read_b64_tr_b16 v[138:139], v6 offset:1024
    ds_read_b64_tr_b16 v[140:141], v7 offset:0
    ds_read_b64_tr_b16 v[142:143], v7 offset:768
    ds_read_b64_tr_b16 v[144:145], v7 offset:64
    ds_read_b64_tr_b16 v[146:147], v7 offset:832
    ds_read_b64_tr_b16 v[148:149], v7 offset:128
    ds_read_b64_tr_b16 v[150:151], v7 offset:896
    s_mov_b32 s44, 0
G1_LOOP:
    s_add_u32 s43, s43, 14336
    s_cmp_ge_u32 s43, 157696
    s_cselect_b32 s43, 0, s43
    v_add_u32 v5, s43, v2
    v_add_u32 v6, s43, v3
    v_add_u32 v7, s43, v4
    s_waitcnt lgkmcnt(10)
    s_barrier
    v_mfma_f32_32x32x16_bf16 v[16:31], v[112:115], v[120:123], v[16:31]
    ds_read_b64_tr_b16 v[152:153], v5
    ds_read_b64_tr_b16 v[154:155], v5 offset:1024
    v_mfma_f32_32x32x16_bf16 v[32:47], v[112:115], v[124:127], v[32:47]
    ds_read_b64_tr_b16 v[156:157], v6
    ds_read_b64_tr_b16 v[158:159], v6 offset:1024
    v_mfma_f32_32x32x16_bf16 v[48:63], v[112:115], v[128:131], v[48:63]
    ds_read_b64_tr_b16 v[160:161], v7 offset:0
    ds_read_b64_tr_b16 v[162:163], v7 offset:768
    v_mfma_f32_32x32x16_bf16 v[64:79], v[116:119], v[120:123], v[64:79]
    ds_read_b64_tr_b16 v[164:165], v7 offset:64
    ds_read_b64_tr_b16 v[166:167], v7 offset:832
    v_mfma_f32_32x32x16_bf16 v[80:95], v[116:119], v[124:127], v[80:95]
    ds_read_b64_tr_b16 v[168:169], v7 offset:128
    ds_read_b64_tr_b16 v[170:171], v7 offset:896
    v_mfma_f32_32x32x16_bf16 v[96:111], v[116:119], v[128:131], v[96:111]
    s_add_u32 s43, s43, 14336
    s_cmp_ge_u32 s43, 157696
    s_cselect_b32 s43, 0, s43
    v_add_u32 v5, s43, v2
    v_add_u32 v6, s43, v3
    v_add_u32 v7, s43, v4
    s_waitcnt lgkmcnt(10)
    s_barrier
    v_mfma_f32_32x32x16_bf16 v[16:31], v[132:135], v[140:143], v[16:31]
    ds_read_b64_tr_b16 v[112:113], v5
    ds_read_b64_tr_b16 v[114:115], v5 offset:1024
    v_mfma_f32_32x32x16_bf16 v[32:47], v[132:135], v[144:147], v[32:47]
    ds_read_b64_tr_b16 v[116:117], v6
    ds_read_b64_tr_b16 v[118:119], v6 offset:1024
    v_mfma_f32_32x32x16_bf16 v[48:63], v[132:135], v[148:151], v[48:63]
    ds_read_b64_tr_b16 v[120:121], v7 offset:0
    ds_read_b64_tr_b16 v[122:123], v7 offset:768
    v_mfma_f32_32x32x16_bf16 v[64:79], v[136:139], v[140:143], v[64:79]
    ds_read_b64_tr_b16 v[124:125], v7 offset:64
    ds_read_b64_tr_b16 v[126:127], v7 offset:832
    v_mfma_f32_32x32x16_bf16 v[80:95], v[136:139], v[144:147], v[80:95]
    ds_read_b64_tr_b16 v[128:129], v7 offset:128
    ds_read_b64_tr_b16 v[130:131], v7 offset:896
    v_mfma_f32_32x32x16_bf16 v[96:111], v[136:139], v[148:151], v[96:111]
    s_add_u32 s43, s43, 14336
    s_cmp_ge_u32 s43, 157696
    s_cselect_b32 s43, 0, s43
    v_add_u32 v5, s43, v2
    v_add_u32 v6, s43, v3
    v_add_u32 v7, s43, v4
    s_waitcnt lgkmcnt(10)
    s_barrier
    v_mfma_f32_32x32x16_bf16 v[16:31], v[152:155], v[160:163], v[16:31]
    ds_read_b64_tr_b16 v[132:133], v5
    ds_read_b64_tr_b16 v[134:135], v5 offset:1024
    v_mfma_f32_32x32x16_bf16 v[32:47], v[152:155], v[164:167], v[32:47]
    ds_read_b64_tr_b16 v[136:137], v6
    ds_read_b64_tr_b16 v[138:139], v6 offset:1024
    v_mfma_f32_32x32x16_bf16 v[48:63], v[152:155], v[168:171], v[48:63]
    ds_read_b64_tr_b16 v[140:141], v7 offset:0
    ds_read_b64_tr_b16 v[142:143], v7 offset:768
    v_mfma_f32_32x32x16_bf16 v[64:79], v[156:159], v[160:163], v[64:79]
    ds_read_b64_tr_b16 v[144:145], v7 offset:64
    ds_read_b64_tr_b16 v[146:147], v7 offset:832
    v_mfma_f32_32x32x16_bf16 v[80:95], v[156:159], v[164:167], v[80:95]
    ds_read_b64_tr_b16 v[148:149], v7 offset:128
    ds_read_b64_tr_b16 v[150:151], v7 offset:896
    v_mfma_f32_32x32x16_bf16 v[96:111], v[156:159], v[168:171], v[96:111]
    s_add_u32 s44, s44, 1
    s_cmp_lt_u32 s44, 21
    s_cbranch_scc1 G1_LOOP
    s_add_u32 s43, s43, 14336
    s_cmp_ge_u32 s43, 157696
    s_cselect_b32 s43, 0, s43
    v_add_u32 v5, s43, v2
    v_add_u32 v6, s43, v3
    v_add_u32 v7, s43, v4
    s_waitcnt lgkmcnt(10)
    s_barrier
    v_mfma_f32_32x32x16_bf16 v[16:31], v[112:115], v[120:123], v[16:31]
    ds_read_b64_tr_b16 v[152:153], v5
    ds_read_b64_tr_b16 v[154:155], v5 offset:1024
    v_mfma_f32_32x32x16_bf16 v[32:47], v[112:115], v[124:127], v[32:47]
    ds_read_b64_tr_b16 v[156:157], v6
    ds_read_b64_tr_b16 v[158:159], v6 offset:1024
    v_mfma_f32_32x32x16_bf16 v[48:63], v[112:115], v[128:131], v[48:63]
    ds_read_b64_tr_b16 v[160:161], v7 offset:0
    ds_read_b64_tr_b16 v[162:163], v7 offset:768
    v_mfma_f32_32x32x16_bf16 v[64:79], v[116:119], v[120:123], v[64:79]
    ds_read_b64_tr_b16 v[164:165], v7 offset:64
    ds_read_b64_tr_b16 v[166:167], v7 offset:832
    v_mfma_f32_32x32x16_bf16 v[80:95], v[116:119], v[124:127], v[80:95]
    ds_read_b64_tr_b16 v[168:169], v7 offset:128
    ds_read_b64_tr_b16 v[170:171], v7 offset:896
    v_mfma_f32_32x32x16_bf16 v[96:111], v[116:119], v[128:131], v[96:111]
    s_waitcnt lgkmcnt(0)
    s_barrier
    v_lshlrev_b32 v2, 4, v1
    s_mul_i32 s45, s3, 24576
    v_add_u32 v3, s45, v2
    ds_write_b128 v3, v[16:19] offset:0
    ds_write_b128 v3, v[20:23] offset:1024
    ds_write_b128 v3, v[24:27] offset:2048
    ds_write_b128 v3, v[28:31] offset:3072
    ds_write_b128 v3, v[32:35] offset:4096
    ds_write_b128 v3, v[36:39] offset:5120
    ds_write_b128 v3, v[40:43] offset:6144
    ds_write_b128 v3, v[44:47] offset:7168
    ds_write_b128 v3, v[48:51] offset:8192
    ds_write_b128 v3, v[52:55] offset:9216
    ds_write_b128 v3, v[56:59] offset:10240
    ds_write_b128 v3, v[60:63] offset:11264
    ds_write_b128 v3, v[64:67] offset:12288
    ds_write_b128 v3, v[68:71] offset:13312
    ds_write_b128 v3, v[72:75] offset:14336
    ds_write_b128 v3, v[76:79] offset:15360
    ds_write_b128 v3, v[80:83] offset:16384
    ds_write_b128 v3, v[84:87] offset:17408
    ds_write_b128 v3, v[88:91] offset:18432
    ds_write_b128 v3, v[92:95] offset:19456
    ds_write_b128 v3, v[96:99] offset:20480
    ds_write_b128 v3, v[100:103] offset:21504
    ds_write_b128 v3, v[104:107] offset:22528
    ds_write_b128 v3, v[108:111] offset:23552
G1_EPI:
    s_lshr_b32 s41, s3, 2
    s_bfe_u32 s40, s3, 0x10001
    s_and_b32 s42, s3, 1
    s_lshl_b32 s45, s41, 7
    s_lshl_b32 s46, s40, 6
    s_add_u32 s45, s45, s46
    s_lshl_b32 s46, s42, 5
    s_add_u32 s45, s45, s46
    s_add_u32 s45, s45, s31
    v_lshrrev_b32 v5, 5, v1
    v_lshlrev_b32 v5, 3, v5
    buffer_load_dwordx2 v[176:177], v5, s[20:23], s45 offen offset:0
    buffer_load_dwordx2 v[178:179], v5, s[20:23], s45 offen offset:16
    v_lshlrev_b32 v2, 4, v1
    s_mul_i32 s46, s41, 49152
    s_mul_i32 s47, s40, 12288
    s_add_u32 s46, s46, s47
    s_lshl_b32 s47, s42, 11
    s_add_u32 s46, s46, s47
    v_add_u32 v4, s46, v2
    s_waitcnt lgkmcnt(0)
    s_barrier
    ds_read_b128 v[16:19], v4 offset:0
    ds_read_b128 v[40:43], v4 offset:24576
    ds_read_b128 v[20:23], v4 offset:1024
    ds_read_b128 v[44:47], v4 offset:25600
    ds_read_b128 v[24:27], v4 offset:4096
    ds_read_b128 v[48:51], v4 offset:28672
    ds_read_b128 v[28:31], v4 offset:5120
    ds_read_b128 v[52:55], v4 offset:29696
    ds_read_b128 v[32:35], v4 offset:8192
    ds_read_b128 v[56:59], v4 offset:32768
    ds_read_b128 v[36:39], v4 offset:9216
    ds_read_b128 v[60:63], v4 offset:33792
    v_and_b32 v6, 31, v1
    v_mul_u32_u24 v6, 10368, v6
    v_lshrrev_b32 v7, 5, v1
    v_lshl_add_u32 v6, v7, 4, v6
    s_mul_i32 s46, s30, 995328
    s_add_u32 s46, s46, s45
    s_add_u32 s46, s46, 7210112
    v_mov_b32 v8, 0x3d372713
    v_mov_b32 v9, 0x3d372713
    v_mov_b32 v10, 0xc0135761
    v_mov_b32 v11, 0xc0135761
    v_mov_b32 v12, 1.0
    v_mov_b32 v13, 1.0
    s_waitcnt vmcnt(0)
    v_lshlrev_b32 v64, 16, v176
    v_and_b32 v65, 0xffff0000, v176
    v_lshlrev_b32 v66, 16, v177
    v_and_b32 v67, 0xffff0000, v177
    v_lshlrev_b32 v68, 16, v178
    v_and_b32 v69, 0xffff0000, v178
    v_lshlrev_b32 v70, 16, v179
    v_and_b32 v71, 0xffff0000, v179
    s_waitcnt lgkmcnt(0)
    v_pk_add_f32 v[16:17], v[16:17], v[40:41]
    v_pk_add_f32 v[18:19], v[18:19], v[42:43]
    v_pk_add_f32 v[20:21], v[20:21], v[44:45]
    v_pk_add_f32 v[22:23], v[22:23], v[46:47]
    v_pk_add_f32 v[24:25], v[24:25], v[48:49]
    v_pk_add_f32 v[26:27], v[26:27], v[50:51]
    v_pk_add_f32 v[28:29], v[28:29], v[52:53]
    v_pk_add_f32 v[30:31], v[30:31], v[54:55]
    v_pk_add_f32 v[32:33], v[32:33], v[56:57]
    v_pk_add_f32 v[34:35], v[34:35], v[58:59]
    v_pk_add_f32 v[36:37], v[36:37], v[60:61]
    v_pk_add_f32 v[38:39], v[38:39], v[62:63]
    v_cvt_pk_bf16_f32 v80, v16, v17
    v_cvt_pk_bf16_f32 v81, v18, v19
    v_cvt_pk_bf16_f32 v82, v20, v21
    v_cvt_pk_bf16_f32 v83, v22, v23
    v_lshlrev_b32 v16, 16, v80
    v_and_b32 v17, 0xffff0000, v80
    v_lshlrev_b32 v18, 16, v81
    v_and_b32 v19, 0xffff0000, v81
    v_lshlrev_b32 v20, 16, v82
    v_and_b32 v21, 0xffff0000, v82
    v_lshlrev_b32 v22, 16, v83
    v_and_b32 v23, 0xffff0000, v83
    v_pk_add_f32 v[16:17], v[16:17], v[64:65]
    v_pk_add_f32 v[18:19], v[18:19], v[66:67]
    v_pk_add_f32 v[20:21], v[20:21], v[68:69]
    v_pk_add_f32 v[22:23], v[22:23], v[70:71]
    v_cvt_pk_bf16_f32 v80, v16, v17
    v_cvt_pk_bf16_f32 v81, v18, v19
    v_cvt_pk_bf16_f32 v82, v20, v21
    v_cvt_pk_bf16_f32 v83, v22, v23
    v_lshlrev_b32 v16, 16, v80
    v_and_b32 v17, 0xffff0000, v80
    v_lshlrev_b32 v18, 16, v81
    v_and_b32 v19, 0xffff0000, v81
    v_lshlrev_b32 v20, 16, v82
    v_and_b32 v21, 0xffff0000, v82
    v_lshlrev_b32 v22, 16, v83
    v_and_b32 v23, 0xffff0000, v83
    v_pk_mul_f32 v[80:81], v[16:17], v[16:17]
    v_pk_mul_f32 v[82:83], v[18:19], v[18:19]
    v_pk_mul_f32 v[84:85], v[20:21], v[20:21]
    v_pk_mul_f32 v[86:87], v[22:23], v[22:23]
    v_pk_fma_f32 v[80:81], v[80:81], v[8:9], v[12:13]
    v_pk_fma_f32 v[82:83], v[82:83], v[8:9], v[12:13]
    v_pk_fma_f32 v[84:85], v[84:85], v[8:9], v[12:13]
    v_pk_fma_f32 v[86:87], v[86:87], v[8:9], v[12:13]
    v_pk_mul_f32 v[88:89], v[16:17], v[10:11]
    v_pk_mul_f32 v[90:91], v[18:19], v[10:11]
    v_pk_mul_f32 v[92:93], v[20:21], v[10:11]
    v_pk_mul_f32 v[94:95], v[22:23], v[10:11]
    v_pk_mul_f32 v[80:81], v[80:81], v[88:89]
    v_pk_mul_f32 v[82:83], v[82:83], v[90:91]
    v_pk_mul_f32 v[84:85], v[84:85], v[92:93]
    v_pk_mul_f32 v[86:87], v[86:87], v[94:95]
    v_exp_f32 v80, v80
    v_exp_f32 v81, v81
    v_exp_f32 v82, v82
    v_exp_f32 v83, v83
    v_exp_f32 v84, v84
    v_exp_f32 v85, v85
    v_exp_f32 v86, v86
    v_exp_f32 v87, v87
    v_pk_add_f32 v[80:81], v[80:81], v[12:13]
    v_pk_add_f32 v[82:83], v[82:83], v[12:13]
    v_pk_add_f32 v[84:85], v[84:85], v[12:13]
    v_pk_add_f32 v[86:87], v[86:87], v[12:13]
    v_rcp_f32 v80, v80
    v_rcp_f32 v81, v81
    v_rcp_f32 v82, v82
    v_rcp_f32 v83, v83
    v_rcp_f32 v84, v84
    v_rcp_f32 v85, v85
    v_rcp_f32 v86, v86
    v_rcp_f32 v87, v87
    v_pk_mul_f32 v[16:17], v[16:17], v[80:81]
    v_pk_mul_f32 v[18:19], v[18:19], v[82:83]
    v_pk_mul_f32 v[20:21], v[20:21], v[84:85]
    v_pk_mul_f32 v[22:23], v[22:23], v[86:87]
    v_cvt_pk_bf16_f32 v100, v16, v17
    v_cvt_pk_bf16_f32 v101, v18, v19
    v_cvt_pk_bf16_f32 v102, v20, v21
    v_cvt_pk_bf16_f32 v103, v22, v23
    s_nop 0
    v_permlane32_swap_b32 v100, v102
    v_permlane32_swap_b32 v101, v103
    s_add_u32 s49, s46, 0
    buffer_store_dwordx4 v[100:103], v6, s[24:27], s49 offen
    v_cvt_pk_bf16_f32 v80, v24, v25
    v_cvt_pk_bf16_f32 v81, v26, v27
    v_cvt_pk_bf16_f32 v82, v28, v29
    v_cvt_pk_bf16_f32 v83, v30, v31
    v_lshlrev_b32 v24, 16, v80
    v_and_b32 v25, 0xffff0000, v80
    v_lshlrev_b32 v26, 16, v81
    v_and_b32 v27, 0xffff0000, v81
    v_lshlrev_b32 v28, 16, v82
    v_and_b32 v29, 0xffff0000, v82
    v_lshlrev_b32 v30, 16, v83
    v_and_b32 v31, 0xffff0000, v83
    v_pk_add_f32 v[24:25], v[24:25], v[64:65]
    v_pk_add_f32 v[26:27], v[26:27], v[66:67]
    v_pk_add_f32 v[28:29], v[28:29], v[68:69]
    v_pk_add_f32 v[30:31], v[30:31], v[70:71]
    v_cvt_pk_bf16_f32 v80, v24, v25
    v_cvt_pk_bf16_f32 v81, v26, v27
    v_cvt_pk_bf16_f32 v82, v28, v29
    v_cvt_pk_bf16_f32 v83, v30, v31
    v_lshlrev_b32 v24, 16, v80
    v_and_b32 v25, 0xffff0000, v80
    v_lshlrev_b32 v26, 16, v81
    v_and_b32 v27, 0xffff0000, v81
    v_lshlrev_b32 v28, 16, v82
    v_and_b32 v29, 0xffff0000, v82
    v_lshlrev_b32 v30, 16, v83
    v_and_b32 v31, 0xffff0000, v83
    v_pk_mul_f32 v[80:81], v[24:25], v[24:25]
    v_pk_mul_f32 v[82:83], v[26:27], v[26:27]
    v_pk_mul_f32 v[84:85], v[28:29], v[28:29]
    v_pk_mul_f32 v[86:87], v[30:31], v[30:31]
    v_pk_fma_f32 v[80:81], v[80:81], v[8:9], v[12:13]
    v_pk_fma_f32 v[82:83], v[82:83], v[8:9], v[12:13]
    v_pk_fma_f32 v[84:85], v[84:85], v[8:9], v[12:13]
    v_pk_fma_f32 v[86:87], v[86:87], v[8:9], v[12:13]
    v_pk_mul_f32 v[88:89], v[24:25], v[10:11]
    v_pk_mul_f32 v[90:91], v[26:27], v[10:11]
    v_pk_mul_f32 v[92:93], v[28:29], v[10:11]
    v_pk_mul_f32 v[94:95], v[30:31], v[10:11]
    v_pk_mul_f32 v[80:81], v[80:81], v[88:89]
    v_pk_mul_f32 v[82:83], v[82:83], v[90:91]
    v_pk_mul_f32 v[84:85], v[84:85], v[92:93]
    v_pk_mul_f32 v[86:87], v[86:87], v[94:95]
    v_exp_f32 v80, v80
    v_exp_f32 v81, v81
    v_exp_f32 v82, v82
    v_exp_f32 v83, v83
    v_exp_f32 v84, v84
    v_exp_f32 v85, v85
    v_exp_f32 v86, v86
    v_exp_f32 v87, v87
    v_pk_add_f32 v[80:81], v[80:81], v[12:13]
    v_pk_add_f32 v[82:83], v[82:83], v[12:13]
    v_pk_add_f32 v[84:85], v[84:85], v[12:13]
    v_pk_add_f32 v[86:87], v[86:87], v[12:13]
    v_rcp_f32 v80, v80
    v_rcp_f32 v81, v81
    v_rcp_f32 v82, v82
    v_rcp_f32 v83, v83
    v_rcp_f32 v84, v84
    v_rcp_f32 v85, v85
    v_rcp_f32 v86, v86
    v_rcp_f32 v87, v87
    v_pk_mul_f32 v[24:25], v[24:25], v[80:81]
    v_pk_mul_f32 v[26:27], v[26:27], v[82:83]
    v_pk_mul_f32 v[28:29], v[28:29], v[84:85]
    v_pk_mul_f32 v[30:31], v[30:31], v[86:87]
    v_cvt_pk_bf16_f32 v104, v24, v25
    v_cvt_pk_bf16_f32 v105, v26, v27
    v_cvt_pk_bf16_f32 v106, v28, v29
    v_cvt_pk_bf16_f32 v107, v30, v31
    s_nop 0
    v_permlane32_swap_b32 v104, v106
    v_permlane32_swap_b32 v105, v107
    s_add_u32 s49, s46, 331776
    buffer_store_dwordx4 v[104:107], v6, s[24:27], s49 offen
    v_cvt_pk_bf16_f32 v80, v32, v33
    v_cvt_pk_bf16_f32 v81, v34, v35
    v_cvt_pk_bf16_f32 v82, v36, v37
    v_cvt_pk_bf16_f32 v83, v38, v39
    v_lshlrev_b32 v32, 16, v80
    v_and_b32 v33, 0xffff0000, v80
    v_lshlrev_b32 v34, 16, v81
    v_and_b32 v35, 0xffff0000, v81
    v_lshlrev_b32 v36, 16, v82
    v_and_b32 v37, 0xffff0000, v82
    v_lshlrev_b32 v38, 16, v83
    v_and_b32 v39, 0xffff0000, v83
    v_pk_add_f32 v[32:33], v[32:33], v[64:65]
    v_pk_add_f32 v[34:35], v[34:35], v[66:67]
    v_pk_add_f32 v[36:37], v[36:37], v[68:69]
    v_pk_add_f32 v[38:39], v[38:39], v[70:71]
    v_cvt_pk_bf16_f32 v80, v32, v33
    v_cvt_pk_bf16_f32 v81, v34, v35
    v_cvt_pk_bf16_f32 v82, v36, v37
    v_cvt_pk_bf16_f32 v83, v38, v39
    v_lshlrev_b32 v32, 16, v80
    v_and_b32 v33, 0xffff0000, v80
    v_lshlrev_b32 v34, 16, v81
    v_and_b32 v35, 0xffff0000, v81
    v_lshlrev_b32 v36, 16, v82
    v_and_b32 v37, 0xffff0000, v82
    v_lshlrev_b32 v38, 16, v83
    v_and_b32 v39, 0xffff0000, v83
    v_pk_mul_f32 v[80:81], v[32:33], v[32:33]
    v_pk_mul_f32 v[82:83], v[34:35], v[34:35]
    v_pk_mul_f32 v[84:85], v[36:37], v[36:37]
    v_pk_mul_f32 v[86:87], v[38:39], v[38:39]
    v_pk_fma_f32 v[80:81], v[80:81], v[8:9], v[12:13]
    v_pk_fma_f32 v[82:83], v[82:83], v[8:9], v[12:13]
    v_pk_fma_f32 v[84:85], v[84:85], v[8:9], v[12:13]
    v_pk_fma_f32 v[86:87], v[86:87], v[8:9], v[12:13]
    v_pk_mul_f32 v[88:89], v[32:33], v[10:11]
    v_pk_mul_f32 v[90:91], v[34:35], v[10:11]
    v_pk_mul_f32 v[92:93], v[36:37], v[10:11]
    v_pk_mul_f32 v[94:95], v[38:39], v[10:11]
    v_pk_mul_f32 v[80:81], v[80:81], v[88:89]
    v_pk_mul_f32 v[82:83], v[82:83], v[90:91]
    v_pk_mul_f32 v[84:85], v[84:85], v[92:93]
    v_pk_mul_f32 v[86:87], v[86:87], v[94:95]
    v_exp_f32 v80, v80
    v_exp_f32 v81, v81
    v_exp_f32 v82, v82
    v_exp_f32 v83, v83
    v_exp_f32 v84, v84
    v_exp_f32 v85, v85
    v_exp_f32 v86, v86
    v_exp_f32 v87, v87
    v_pk_add_f32 v[80:81], v[80:81], v[12:13]
    v_pk_add_f32 v[82:83], v[82:83], v[12:13]
    v_pk_add_f32 v[84:85], v[84:85], v[12:13]
    v_pk_add_f32 v[86:87], v[86:87], v[12:13]
    v_rcp_f32 v80, v80
    v_rcp_f32 v81, v81
    v_rcp_f32 v82, v82
    v_rcp_f32 v83, v83
    v_rcp_f32 v84, v84
    v_rcp_f32 v85, v85
    v_rcp_f32 v86, v86
    v_rcp_f32 v87, v87
    v_pk_mul_f32 v[32:33], v[32:33], v[80:81]
    v_pk_mul_f32 v[34:35], v[34:35], v[82:83]
    v_pk_mul_f32 v[36:37], v[36:37], v[84:85]
    v_pk_mul_f32 v[38:39], v[38:39], v[86:87]
    v_cvt_pk_bf16_f32 v108, v32, v33
    v_cvt_pk_bf16_f32 v109, v34, v35
    v_cvt_pk_bf16_f32 v110, v36, v37
    v_cvt_pk_bf16_f32 v111, v38, v39
    s_nop 0
    v_permlane32_swap_b32 v108, v110
    v_permlane32_swap_b32 v109, v111
    s_add_u32 s49, s46, 663552
    buffer_store_dwordx4 v[108:111], v6, s[24:27], s49 offen
    s_endpgm
K2_FFT:
    s_lshl_b32 s31, s28, 1
    s_lshl_b32 s32, s28, 3
    s_sub_u32 s32, s32, 24
    s_cmp_lt_u32 s28, 4
    s_cselect_b32 s31, s31, s32
    s_sub_u32 s29, s29, s30
    s_add_u32 s28, s31, s29
    s_lshl_b32 s28, s28, 3
    s_add_u32 s28, s28, s3
    s_min_u32 s29, s28, 288
    v_lshlrev_b32 v2, 4, v1
    s_mul_i32 s30, s3, 6144
    s_add_u32 s31, s30, 0
    s_mov_b32 m0, s31
    s_add_u32 s32, s31, 15622144
    buffer_load_dwordx4 v2, s[24:27], s32 offen lds
    s_add_u32 s31, s30, 1024
    s_mov_b32 m0, s31
    s_add_u32 s32, s31, 15622144
    buffer_load_dwordx4 v2, s[24:27], s32 offen lds
    s_add_u32 s31, s30, 2048
    s_mov_b32 m0, s31
    s_add_u32 s32, s31, 15622144
    buffer_load_dwordx4 v2, s[24:27], s32 offen lds
    s_add_u32 s31, s30, 3072
    s_mov_b32 m0, s31
    s_add_u32 s32, s31, 15622144
    buffer_load_dwordx4 v2, s[24:27], s32 offen lds
    s_add_u32 s31, s30, 4096
    s_mov_b32 m0, s31
    s_add_u32 s32, s31, 15622144
    buffer_load_dwordx4 v2, s[24:27], s32 offen lds
    s_add_u32 s31, s30, 5120
    s_mov_b32 m0, s31
    s_add_u32 s32, s31, 15622144
    buffer_load_dwordx4 v2, s[24:27], s32 offen lds
    s_lshl_b32 s33, s29, 13
    s_lshl_b32 s34, s3, 13
    s_add_u32 s34, s34, 49152
    s_add_u32 s31, s34, 0
    s_mov_b32 m0, s31
    s_add_u32 s32, s33, 4784128
    buffer_load_dwordx4 v2, s[24:27], s32 offen lds
    s_add_u32 s31, s34, 1024
    s_mov_b32 m0, s31
    s_add_u32 s32, s33, 4785152
    buffer_load_dwordx4 v2, s[24:27], s32 offen lds
    s_add_u32 s31, s34, 2048
    s_mov_b32 m0, s31
    s_add_u32 s32, s33, 4786176
    buffer_load_dwordx4 v2, s[24:27], s32 offen lds
    s_add_u32 s31, s34, 3072
    s_mov_b32 m0, s31
    s_add_u32 s32, s33, 4787200
    buffer_load_dwordx4 v2, s[24:27], s32 offen lds
    s_add_u32 s31, s34, 4096
    s_mov_b32 m0, s31
    s_add_u32 s32, s33, 4788224
    buffer_load_dwordx4 v2, s[24:27], s32 offen lds
    s_add_u32 s31, s34, 5120
    s_mov_b32 m0, s31
    s_add_u32 s32, s33, 4789248
    buffer_load_dwordx4 v2, s[24:27], s32 offen lds
    s_add_u32 s31, s34, 6144
    s_mov_b32 m0, s31
    s_add_u32 s32, s33, 4790272
    buffer_load_dwordx4 v2, s[24:27], s32 offen lds
    s_add_u32 s31, s34, 7168
    s_mov_b32 m0, s31
    s_add_u32 s32, s33, 4791296
    buffer_load_dwordx4 v2, s[24:27], s32 offen lds
    v_lshrrev_b32 v3, 5, v1
    v_lshlrev_b32 v3, 10, v3
    v_and_b32 v4, 31, v1
    v_lshl_add_u32 v3, v4, 4, v3
    s_add_u32 s35, s33, 2359296
    buffer_load_dwordx4 v[112:115], v3, s[24:27], s35 offen offset:0
    buffer_load_dwordx4 v[128:131], v3, s[24:27], s35 offen offset:512
    s_add_u32 s35, s33, 2361344
    buffer_load_dwordx4 v[116:119], v3, s[24:27], s35 offen offset:0
    buffer_load_dwordx4 v[132:135], v3, s[24:27], s35 offen offset:512
    s_add_u32 s35, s33, 2363392
    buffer_load_dwordx4 v[120:123], v3, s[24:27], s35 offen offset:0
    buffer_load_dwordx4 v[136:139], v3, s[24:27], s35 offen offset:512
    s_add_u32 s35, s33, 2365440
    buffer_load_dwordx4 v[124:127], v3, s[24:27], s35 offen offset:0
    buffer_load_dwordx4 v[140:143], v3, s[24:27], s35 offen offset:512
    s_mov_b32 s35, 15597568
    buffer_load_dwordx4 v[16:19], v2, s[24:27], s35 offen offset:0
    buffer_load_dwordx4 v[20:23], v2, s[24:27], s35 offen offset:1024
    buffer_load_dwordx4 v[24:27], v2, s[24:27], s35 offen offset:2048
    buffer_load_dwordx4 v[28:31], v2, s[24:27], s35 offen offset:3072
    s_mov_b32 s35, 15601664
    buffer_load_dwordx4 v[32:35], v2, s[24:27], s35 offen offset:0
    buffer_load_dwordx4 v[36:39], v2, s[24:27], s35 offen offset:1024
    buffer_load_dwordx4 v[40:43], v2, s[24:27], s35 offen offset:2048
    buffer_load_dwordx4 v[44:47], v2, s[24:27], s35 offen offset:3072
    s_mov_b32 s35, 15605760
    buffer_load_dwordx4 v[48:51], v2, s[24:27], s35 offen offset:0
    buffer_load_dwordx4 v[52:55], v2, s[24:27], s35 offen offset:1024
    buffer_load_dwordx4 v[56:59], v2, s[24:27], s35 offen offset:2048
    buffer_load_dwordx4 v[60:63], v2, s[24:27], s35 offen offset:3072
    s_mov_b32 s35, 15609856
    buffer_load_dwordx4 v[64:67], v2, s[24:27], s35 offen offset:0
    buffer_load_dwordx4 v[68:71], v2, s[24:27], s35 offen offset:1024
    buffer_load_dwordx4 v[72:75], v2, s[24:27], s35 offen offset:2048
    buffer_load_dwordx4 v[76:79], v2, s[24:27], s35 offen offset:3072
    s_mov_b32 s35, 15613952
    buffer_load_dwordx4 v[80:83], v2, s[24:27], s35 offen offset:0
    buffer_load_dwordx4 v[84:87], v2, s[24:27], s35 offen offset:1024
    buffer_load_dwordx4 v[88:91], v2, s[24:27], s35 offen offset:2048
    buffer_load_dwordx4 v[92:95], v2, s[24:27], s35 offen offset:3072
    s_mov_b32 s35, 15618048
    buffer_load_dwordx4 v[96:99], v2, s[24:27], s35 offen offset:0
    buffer_load_dwordx4 v[100:103], v2, s[24:27], s35 offen offset:1024
    buffer_load_dwordx4 v[104:107], v2, s[24:27], s35 offen offset:2048
    buffer_load_dwordx4 v[108:111], v2, s[24:27], s35 offen offset:3072
    v_and_b32 v7, 1, v1
    v_lshlrev_b32 v7, 31, v7
    v_xor_b32 v5, 1.0, v7
    v_xor_b32 v6, -1.0, v7
    v_lshrrev_b32 v8, 5, v1
    v_bfe_u32 v9, v1, 1, 4
    v_lshl_add_u32 v8, v8, 4, v9
    v_lshlrev_b32 v8, 4, v8
    v_add_u32 v8, s34, v8
    s_waitcnt vmcnt(0)
    s_barrier
    s_cmp_gt_u32 s28, 288
    s_cbranch_scc1 K2_END
    v_mov_b32 v144, 0
    v_mov_b32 v145, 0
    v_mov_b32 v146, 0
    v_mov_b32 v147, 0
    v_mov_b32 v148, 0
    v_mov_b32 v149, 0
    v_mov_b32 v150, 0
    v_mov_b32 v151, 0
    v_mov_b32 v152, 0
    v_mov_b32 v153, 0
    v_mov_b32 v154, 0
    v_mov_b32 v155, 0
    v_mov_b32 v156, 0
    v_mov_b32 v157, 0
    v_mov_b32 v158, 0
    v_mov_b32 v159, 0
    v_mov_b32 v160, 0
    v_mov_b32 v161, 0
    v_mov_b32 v162, 0
    v_mov_b32 v163, 0
    v_mov_b32 v164, 0
    v_mov_b32 v165, 0
    v_mov_b32 v166, 0
    v_mov_b32 v167, 0
    v_mov_b32 v168, 0
    v_mov_b32 v169, 0
    v_mov_b32 v170, 0
    v_mov_b32 v171, 0
    v_mov_b32 v172, 0
    v_mov_b32 v173, 0
    v_mov_b32 v174, 0
    v_mov_b32 v175, 0
    v_mov_b32 v176, 0
    v_mov_b32 v177, 0
    v_mov_b32 v178, 0
    v_mov_b32 v179, 0
    v_mov_b32 v180, 0
    v_mov_b32 v181, 0
    v_mov_b32 v182, 0
    v_mov_b32 v183, 0
    v_mov_b32 v184, 0
    v_mov_b32 v185, 0
    v_mov_b32 v186, 0
    v_mov_b32 v187, 0
    v_mov_b32 v188, 0
    v_mov_b32 v189, 0
    v_mov_b32 v190, 0
    v_mov_b32 v191, 0
    v_mov_b32 v192, 0
    v_mov_b32 v193, 0
    v_mov_b32 v194, 0
    v_mov_b32 v195, 0
    v_mov_b32 v196, 0
    v_mov_b32 v197, 0
    v_mov_b32 v198, 0
    v_mov_b32 v199, 0
    v_mov_b32 v200, 0
    v_mov_b32 v201, 0
    v_mov_b32 v202, 0
    v_mov_b32 v203, 0
    v_mov_b32 v204, 0
    v_mov_b32 v205, 0
    v_mov_b32 v206, 0
    v_mov_b32 v207, 0
    v_mfma_f32_32x32x16_f16 v[144:159], v[112:115], v[16:19], v[144:159]
    v_mfma_f32_32x32x16_f16 v[144:159], v[116:119], v[20:23], v[144:159]
    v_mfma_f32_32x32x16_f16 v[144:159], v[120:123], v[24:27], v[144:159]
    v_mfma_f32_32x32x16_f16 v[144:159], v[124:127], v[28:31], v[144:159]
    v_mfma_f32_32x32x16_f16 v[160:175], v[112:115], v[32:35], v[160:175]
    v_mfma_f32_32x32x16_f16 v[160:175], v[116:119], v[36:39], v[160:175]
    v_mfma_f32_32x32x16_f16 v[160:175], v[120:123], v[40:43], v[160:175]
    v_mfma_f32_32x32x16_f16 v[160:175], v[124:127], v[44:47], v[160:175]
    v_mfma_f32_32x32x16_f16 v[176:191], v[128:131], v[16:19], v[176:191]
    v_mfma_f32_32x32x16_f16 v[176:191], v[132:135], v[20:23], v[176:191]
    v_mfma_f32_32x32x16_f16 v[176:191], v[136:139], v[24:27], v[176:191]
    v_mfma_f32_32x32x16_f16 v[176:191], v[140:143], v[28:31], v[176:191]
    v_mfma_f32_32x32x16_f16 v[192:207], v[128:131], v[32:35], v[192:207]
    v_mfma_f32_32x32x16_f16 v[192:207], v[132:135], v[36:39], v[192:207]
    v_mfma_f32_32x32x16_f16 v[192:207], v[136:139], v[40:43], v[192:207]
    v_mfma_f32_32x32x16_f16 v[192:207], v[140:143], v[44:47], v[192:207]
    ds_read_b128 v[240:243], v2 offset:0
    ds_read_b128 v[244:247], v2 offset:1024
    ds_read_b128 v[248:251], v2 offset:2048
    ds_read_b128 v[252:255], v2 offset:3072
    s_waitcnt lgkmcnt(0)
    v_mul_f32 v240, v144, v240
    s_nop 1
    v_fmac_f32_dpp v240, v144, v241 quad_perm:[1,0,3,2] row_mask:0xf bank_mask:0xf
    v_mul_f32 v242, v145, v242
    s_nop 1
    v_fmac_f32_dpp v242, v145, v243 quad_perm:[1,0,3,2] row_mask:0xf bank_mask:0xf
    v_cvt_pk_f16_f32 v112, v240, v242
    v_mul_f32 v244, v146, v244
    s_nop 1
    v_fmac_f32_dpp v244, v146, v245 quad_perm:[1,0,3,2] row_mask:0xf bank_mask:0xf
    v_mul_f32 v246, v147, v246
    s_nop 1
    v_fmac_f32_dpp v246, v147, v247 quad_perm:[1,0,3,2] row_mask:0xf bank_mask:0xf
    v_cvt_pk_f16_f32 v113, v244, v246
    v_mul_f32 v248, v148, v248
    s_nop 1
    v_fmac_f32_dpp v248, v148, v249 quad_perm:[1,0,3,2] row_mask:0xf bank_mask:0xf
    v_mul_f32 v250, v149, v250
    s_nop 1
    v_fmac_f32_dpp v250, v149, v251 quad_perm:[1,0,3,2] row_mask:0xf bank_mask:0xf
    v_cvt_pk_f16_f32 v114, v248, v250
    v_mul_f32 v252, v150, v252
    s_nop 1
    v_fmac_f32_dpp v252, v150, v253 quad_perm:[1,0,3,2] row_mask:0xf bank_mask:0xf
    v_mul_f32 v254, v151, v254
    s_nop 1
    v_fmac_f32_dpp v254, v151, v255 quad_perm:[1,0,3,2] row_mask:0xf bank_mask:0xf
    v_cvt_pk_f16_f32 v115, v252, v254
    ds_read_b128 v[240:243], v2 offset:4096
    ds_read_b128 v[244:247], v2 offset:5120
    ds_read_b128 v[248:251], v2 offset:6144
    ds_read_b128 v[252:255], v2 offset:7168
    s_waitcnt lgkmcnt(0)
    v_mul_f32 v240, v152, v240
    s_nop 1
    v_fmac_f32_dpp v240, v152, v241 quad_perm:[1,0,3,2] row_mask:0xf bank_mask:0xf
    v_mul_f32 v242, v153, v242
    s_nop 1
    v_fmac_f32_dpp v242, v153, v243 quad_perm:[1,0,3,2] row_mask:0xf bank_mask:0xf
    v_cvt_pk_f16_f32 v116, v240, v242
    v_mul_f32 v244, v154, v244
    s_nop 1
    v_fmac_f32_dpp v244, v154, v245 quad_perm:[1,0,3,2] row_mask:0xf bank_mask:0xf
    v_mul_f32 v246, v155, v246
    s_nop 1
    v_fmac_f32_dpp v246, v155, v247 quad_perm:[1,0,3,2] row_mask:0xf bank_mask:0xf
    v_cvt_pk_f16_f32 v117, v244, v246
    v_mul_f32 v248, v156, v248
    s_nop 1
    v_fmac_f32_dpp v248, v156, v249 quad_perm:[1,0,3,2] row_mask:0xf bank_mask:0xf
    v_mul_f32 v250, v157, v250
    s_nop 1
    v_fmac_f32_dpp v250, v157, v251 quad_perm:[1,0,3,2] row_mask:0xf bank_mask:0xf
    v_cvt_pk_f16_f32 v118, v248, v250
    v_mul_f32 v252, v158, v252
    s_nop 1
    v_fmac_f32_dpp v252, v158, v253 quad_perm:[1,0,3,2] row_mask:0xf bank_mask:0xf
    v_mul_f32 v254, v159, v254
    s_nop 1
    v_fmac_f32_dpp v254, v159, v255 quad_perm:[1,0,3,2] row_mask:0xf bank_mask:0xf
    v_cvt_pk_f16_f32 v119, v252, v254
    ds_read_b128 v[240:243], v2 offset:8192
    ds_read_b128 v[244:247], v2 offset:9216
    ds_read_b128 v[248:251], v2 offset:10240
    ds_read_b128 v[252:255], v2 offset:11264
    s_waitcnt lgkmcnt(0)
    v_mul_f32 v240, v160, v240
    s_nop 1
    v_fmac_f32_dpp v240, v160, v241 quad_perm:[1,0,3,2] row_mask:0xf bank_mask:0xf
    v_mul_f32 v242, v161, v242
    s_nop 1
    v_fmac_f32_dpp v242, v161, v243 quad_perm:[1,0,3,2] row_mask:0xf bank_mask:0xf
    v_cvt_pk_f16_f32 v128, v240, v242
    v_mul_f32 v244, v162, v244
    s_nop 1
    v_fmac_f32_dpp v244, v162, v245 quad_perm:[1,0,3,2] row_mask:0xf bank_mask:0xf
    v_mul_f32 v246, v163, v246
    s_nop 1
    v_fmac_f32_dpp v246, v163, v247 quad_perm:[1,0,3,2] row_mask:0xf bank_mask:0xf
    v_cvt_pk_f16_f32 v129, v244, v246
    v_mul_f32 v248, v164, v248
    s_nop 1
    v_fmac_f32_dpp v248, v164, v249 quad_perm:[1,0,3,2] row_mask:0xf bank_mask:0xf
    v_mul_f32 v250, v165, v250
    s_nop 1
    v_fmac_f32_dpp v250, v165, v251 quad_perm:[1,0,3,2] row_mask:0xf bank_mask:0xf
    v_cvt_pk_f16_f32 v130, v248, v250
    v_mul_f32 v252, v166, v252
    s_nop 1
    v_fmac_f32_dpp v252, v166, v253 quad_perm:[1,0,3,2] row_mask:0xf bank_mask:0xf
    v_mul_f32 v254, v167, v254
    s_nop 1
    v_fmac_f32_dpp v254, v167, v255 quad_perm:[1,0,3,2] row_mask:0xf bank_mask:0xf
    v_cvt_pk_f16_f32 v131, v252, v254
    ds_read_b128 v[240:243], v2 offset:12288
    ds_read_b128 v[244:247], v2 offset:13312
    ds_read_b128 v[248:251], v2 offset:14336
    ds_read_b128 v[252:255], v2 offset:15360
    s_waitcnt lgkmcnt(0)
    v_mul_f32 v240, v168, v240
    s_nop 1
    v_fmac_f32_dpp v240, v168, v241 quad_perm:[1,0,3,2] row_mask:0xf bank_mask:0xf
    v_mul_f32 v242, v169, v242
    s_nop 1
    v_fmac_f32_dpp v242, v169, v243 quad_perm:[1,0,3,2] row_mask:0xf bank_mask:0xf
    v_cvt_pk_f16_f32 v132, v240, v242
    v_mul_f32 v244, v170, v244
    s_nop 1
    v_fmac_f32_dpp v244, v170, v245 quad_perm:[1,0,3,2] row_mask:0xf bank_mask:0xf
    v_mul_f32 v246, v171, v246
    s_nop 1
    v_fmac_f32_dpp v246, v171, v247 quad_perm:[1,0,3,2] row_mask:0xf bank_mask:0xf
    v_cvt_pk_f16_f32 v133, v244, v246
    v_mul_f32 v248, v172, v248
    s_nop 1
    v_fmac_f32_dpp v248, v172, v249 quad_perm:[1,0,3,2] row_mask:0xf bank_mask:0xf
    v_mul_f32 v250, v173, v250
    s_nop 1
    v_fmac_f32_dpp v250, v173, v251 quad_perm:[1,0,3,2] row_mask:0xf bank_mask:0xf
    v_cvt_pk_f16_f32 v134, v248, v250
    v_mul_f32 v252, v174, v252
    s_nop 1
    v_fmac_f32_dpp v252, v174, v253 quad_perm:[1,0,3,2] row_mask:0xf bank_mask:0xf
    v_mul_f32 v254, v175, v254
    s_nop 1
    v_fmac_f32_dpp v254, v175, v255 quad_perm:[1,0,3,2] row_mask:0xf bank_mask:0xf
    v_cvt_pk_f16_f32 v135, v252, v254
    ds_read_b128 v[240:243], v2 offset:16384
    ds_read_b128 v[244:247], v2 offset:17408
    ds_read_b128 v[248:251], v2 offset:18432
    ds_read_b128 v[252:255], v2 offset:19456
    s_waitcnt lgkmcnt(0)
    v_mul_f32 v240, v176, v240
    s_nop 1
    v_fmac_f32_dpp v240, v176, v241 quad_perm:[1,0,3,2] row_mask:0xf bank_mask:0xf
    v_mul_f32 v242, v177, v242
    s_nop 1
    v_fmac_f32_dpp v242, v177, v243 quad_perm:[1,0,3,2] row_mask:0xf bank_mask:0xf
    v_cvt_pk_f16_f32 v120, v240, v242
    v_mul_f32 v244, v178, v244
    s_nop 1
    v_fmac_f32_dpp v244, v178, v245 quad_perm:[1,0,3,2] row_mask:0xf bank_mask:0xf
    v_mul_f32 v246, v179, v246
    s_nop 1
    v_fmac_f32_dpp v246, v179, v247 quad_perm:[1,0,3,2] row_mask:0xf bank_mask:0xf
    v_cvt_pk_f16_f32 v121, v244, v246
    v_mul_f32 v248, v180, v248
    s_nop 1
    v_fmac_f32_dpp v248, v180, v249 quad_perm:[1,0,3,2] row_mask:0xf bank_mask:0xf
    v_mul_f32 v250, v181, v250
    s_nop 1
    v_fmac_f32_dpp v250, v181, v251 quad_perm:[1,0,3,2] row_mask:0xf bank_mask:0xf
    v_cvt_pk_f16_f32 v122, v248, v250
    v_mul_f32 v252, v182, v252
    s_nop 1
    v_fmac_f32_dpp v252, v182, v253 quad_perm:[1,0,3,2] row_mask:0xf bank_mask:0xf
    v_mul_f32 v254, v183, v254
    s_nop 1
    v_fmac_f32_dpp v254, v183, v255 quad_perm:[1,0,3,2] row_mask:0xf bank_mask:0xf
    v_cvt_pk_f16_f32 v123, v252, v254
    ds_read_b128 v[240:243], v2 offset:20480
    ds_read_b128 v[244:247], v2 offset:21504
    ds_read_b128 v[248:251], v2 offset:22528
    ds_read_b128 v[252:255], v2 offset:23552
    s_waitcnt lgkmcnt(0)
    v_mul_f32 v240, v184, v240
    s_nop 1
    v_fmac_f32_dpp v240, v184, v241 quad_perm:[1,0,3,2] row_mask:0xf bank_mask:0xf
    v_mul_f32 v242, v185, v242
    s_nop 1
    v_fmac_f32_dpp v242, v185, v243 quad_perm:[1,0,3,2] row_mask:0xf bank_mask:0xf
    v_cvt_pk_f16_f32 v124, v240, v242
    v_mul_f32 v244, v186, v244
    s_nop 1
    v_fmac_f32_dpp v244, v186, v245 quad_perm:[1,0,3,2] row_mask:0xf bank_mask:0xf
    v_mul_f32 v246, v187, v246
    s_nop 1
    v_fmac_f32_dpp v246, v187, v247 quad_perm:[1,0,3,2] row_mask:0xf bank_mask:0xf
    v_cvt_pk_f16_f32 v125, v244, v246
    v_mul_f32 v248, v188, v248
    s_nop 1
    v_fmac_f32_dpp v248, v188, v249 quad_perm:[1,0,3,2] row_mask:0xf bank_mask:0xf
    v_mul_f32 v250, v189, v250
    s_nop 1
    v_fmac_f32_dpp v250, v189, v251 quad_perm:[1,0,3,2] row_mask:0xf bank_mask:0xf
    v_cvt_pk_f16_f32 v126, v248, v250
    v_mul_f32 v252, v190, v252
    s_nop 1
    v_fmac_f32_dpp v252, v190, v253 quad_perm:[1,0,3,2] row_mask:0xf bank_mask:0xf
    v_mul_f32 v254, v191, v254
    s_nop 1
    v_fmac_f32_dpp v254, v191, v255 quad_perm:[1,0,3,2] row_mask:0xf bank_mask:0xf
    v_cvt_pk_f16_f32 v127, v252, v254
    ds_read_b128 v[240:243], v2 offset:24576
    ds_read_b128 v[244:247], v2 offset:25600
    ds_read_b128 v[248:251], v2 offset:26624
    ds_read_b128 v[252:255], v2 offset:27648
    s_waitcnt lgkmcnt(0)
    v_mul_f32 v240, v192, v240
    s_nop 1
    v_fmac_f32_dpp v240, v192, v241 quad_perm:[1,0,3,2] row_mask:0xf bank_mask:0xf
    v_mul_f32 v242, v193, v242
    s_nop 1
    v_fmac_f32_dpp v242, v193, v243 quad_perm:[1,0,3,2] row_mask:0xf bank_mask:0xf
    v_cvt_pk_f16_f32 v136, v240, v242
    v_mul_f32 v244, v194, v244
    s_nop 1
    v_fmac_f32_dpp v244, v194, v245 quad_perm:[1,0,3,2] row_mask:0xf bank_mask:0xf
    v_mul_f32 v246, v195, v246
    s_nop 1
    v_fmac_f32_dpp v246, v195, v247 quad_perm:[1,0,3,2] row_mask:0xf bank_mask:0xf
    v_cvt_pk_f16_f32 v137, v244, v246
    v_mul_f32 v248, v196, v248
    s_nop 1
    v_fmac_f32_dpp v248, v196, v249 quad_perm:[1,0,3,2] row_mask:0xf bank_mask:0xf
    v_mul_f32 v250, v197, v250
    s_nop 1
    v_fmac_f32_dpp v250, v197, v251 quad_perm:[1,0,3,2] row_mask:0xf bank_mask:0xf
    v_cvt_pk_f16_f32 v138, v248, v250
    v_mul_f32 v252, v198, v252
    s_nop 1
    v_fmac_f32_dpp v252, v198, v253 quad_perm:[1,0,3,2] row_mask:0xf bank_mask:0xf
    v_mul_f32 v254, v199, v254
    s_nop 1
    v_fmac_f32_dpp v254, v199, v255 quad_perm:[1,0,3,2] row_mask:0xf bank_mask:0xf
    v_cvt_pk_f16_f32 v139, v252, v254
    ds_read_b128 v[240:243], v2 offset:28672
    ds_read_b128 v[244:247], v2 offset:29696
    ds_read_b128 v[248:251], v2 offset:30720
    ds_read_b128 v[252:255], v2 offset:31744
    s_waitcnt lgkmcnt(0)
    v_mul_f32 v240, v200, v240
    s_nop 1
    v_fmac_f32_dpp v240, v200, v241 quad_perm:[1,0,3,2] row_mask:0xf bank_mask:0xf
    v_mul_f32 v242, v201, v242
    s_nop 1
    v_fmac_f32_dpp v242, v201, v243 quad_perm:[1,0,3,2] row_mask:0xf bank_mask:0xf
    v_cvt_pk_f16_f32 v140, v240, v242
    v_mul_f32 v244, v202, v244
    s_nop 1
    v_fmac_f32_dpp v244, v202, v245 quad_perm:[1,0,3,2] row_mask:0xf bank_mask:0xf
    v_mul_f32 v246, v203, v246
    s_nop 1
    v_fmac_f32_dpp v246, v203, v247 quad_perm:[1,0,3,2] row_mask:0xf bank_mask:0xf
    v_cvt_pk_f16_f32 v141, v244, v246
    v_mul_f32 v248, v204, v248
    s_nop 1
    v_fmac_f32_dpp v248, v204, v249 quad_perm:[1,0,3,2] row_mask:0xf bank_mask:0xf
    v_mul_f32 v250, v205, v250
    s_nop 1
    v_fmac_f32_dpp v250, v205, v251 quad_perm:[1,0,3,2] row_mask:0xf bank_mask:0xf
    v_cvt_pk_f16_f32 v142, v248, v250
    v_mul_f32 v252, v206, v252
    s_nop 1
    v_fmac_f32_dpp v252, v206, v253 quad_perm:[1,0,3,2] row_mask:0xf bank_mask:0xf
    v_mul_f32 v254, v207, v254
    s_nop 1
    v_fmac_f32_dpp v254, v207, v255 quad_perm:[1,0,3,2] row_mask:0xf bank_mask:0xf
    v_cvt_pk_f16_f32 v143, v252, v254
    v_mov_b32 v144, 0
    v_mov_b32 v145, 0
    v_mov_b32 v146, 0
    v_mov_b32 v147, 0
    v_mov_b32 v148, 0
    v_mov_b32 v149, 0
    v_mov_b32 v150, 0
    v_mov_b32 v151, 0
    v_mov_b32 v152, 0
    v_mov_b32 v153, 0
    v_mov_b32 v154, 0
    v_mov_b32 v155, 0
    v_mov_b32 v156, 0
    v_mov_b32 v157, 0
    v_mov_b32 v158, 0
    v_mov_b32 v159, 0
    v_mov_b32 v160, 0
    v_mov_b32 v161, 0
    v_mov_b32 v162, 0
    v_mov_b32 v163, 0
    v_mov_b32 v164, 0
    v_mov_b32 v165, 0
    v_mov_b32 v166, 0
    v_mov_b32 v167, 0
    v_mov_b32 v168, 0
    v_mov_b32 v169, 0
    v_mov_b32 v170, 0
    v_mov_b32 v171, 0
    v_mov_b32 v172, 0
    v_mov_b32 v173, 0
    v_mov_b32 v174, 0
    v_mov_b32 v175, 0
    v_mfma_f32_32x32x16_f16 v[144:159], v[48:51], v[112:115], v[144:159]
    v_mfma_f32_32x32x16_f16 v[144:159], v[52:55], v[116:119], v[144:159]
    v_mfma_f32_32x32x16_f16 v[144:159], v[56:59], v[120:123], v[144:159]
    v_mfma_f32_32x32x16_f16 v[144:159], v[60:63], v[124:127], v[144:159]
    v_mfma_f32_32x32x16_f16 v[160:175], v[80:83], v[112:115], v[160:175]
    v_mfma_f32_32x32x16_f16 v[160:175], v[84:87], v[116:119], v[160:175]
    v_mfma_f32_32x32x16_f16 v[160:175], v[88:91], v[120:123], v[160:175]
    v_mfma_f32_32x32x16_f16 v[160:175], v[92:95], v[124:127], v[160:175]
    ds_read_b128 v[240:243], v8 offset:0
    ds_read_b128 v[244:247], v8 offset:512
    ds_read_b128 v[248:251], v8 offset:1024
    ds_read_b128 v[252:255], v8 offset:1536
    s_nop 7
    v_fmac_f32_dpp v144, v160, v5 quad_perm:[1,0,3,2] row_mask:0xf bank_mask:0xf
    v_fmac_f32_dpp v145, v161, v5 quad_perm:[1,0,3,2] row_mask:0xf bank_mask:0xf
    v_fmac_f32_dpp v146, v162, v5 quad_perm:[1,0,3,2] row_mask:0xf bank_mask:0xf
    v_fmac_f32_dpp v147, v163, v5 quad_perm:[1,0,3,2] row_mask:0xf bank_mask:0xf
    v_fmac_f32_dpp v148, v164, v5 quad_perm:[1,0,3,2] row_mask:0xf bank_mask:0xf
    v_fmac_f32_dpp v149, v165, v5 quad_perm:[1,0,3,2] row_mask:0xf bank_mask:0xf
    v_fmac_f32_dpp v150, v166, v5 quad_perm:[1,0,3,2] row_mask:0xf bank_mask:0xf
    v_fmac_f32_dpp v151, v167, v5 quad_perm:[1,0,3,2] row_mask:0xf bank_mask:0xf
    v_fmac_f32_dpp v152, v168, v5 quad_perm:[1,0,3,2] row_mask:0xf bank_mask:0xf
    v_fmac_f32_dpp v153, v169, v5 quad_perm:[1,0,3,2] row_mask:0xf bank_mask:0xf
    v_fmac_f32_dpp v154, v170, v5 quad_perm:[1,0,3,2] row_mask:0xf bank_mask:0xf
    v_fmac_f32_dpp v155, v171, v5 quad_perm:[1,0,3,2] row_mask:0xf bank_mask:0xf
    v_fmac_f32_dpp v156, v172, v5 quad_perm:[1,0,3,2] row_mask:0xf bank_mask:0xf
    v_fmac_f32_dpp v157, v173, v5 quad_perm:[1,0,3,2] row_mask:0xf bank_mask:0xf
    v_fmac_f32_dpp v158, v174, v5 quad_perm:[1,0,3,2] row_mask:0xf bank_mask:0xf
    v_fmac_f32_dpp v159, v175, v5 quad_perm:[1,0,3,2] row_mask:0xf bank_mask:0xf
    s_waitcnt lgkmcnt(0)
    v_mul_f32_dpp v160, v144, v6 quad_perm:[1,0,3,2] row_mask:0xf bank_mask:0xf
    v_fma_mix_f32 v160, v160, v240, 0 op_sel:[0,1,0] op_sel_hi:[0,1,0]
    s_nop 0
    v_fma_mix_f32 v144, v144, v240, v160 op_sel:[0,0,0] op_sel_hi:[0,1,0]
    v_mul_f32_dpp v161, v145, v6 quad_perm:[1,0,3,2] row_mask:0xf bank_mask:0xf
    v_fma_mix_f32 v161, v161, v241, 0 op_sel:[0,1,0] op_sel_hi:[0,1,0]
    s_nop 0
    v_fma_mix_f32 v145, v145, v241, v161 op_sel:[0,0,0] op_sel_hi:[0,1,0]
    v_mul_f32_dpp v162, v146, v6 quad_perm:[1,0,3,2] row_mask:0xf bank_mask:0xf
    v_fma_mix_f32 v162, v162, v242, 0 op_sel:[0,1,0] op_sel_hi:[0,1,0]
    s_nop 0
    v_fma_mix_f32 v146, v146, v242, v162 op_sel:[0,0,0] op_sel_hi:[0,1,0]
    v_mul_f32_dpp v163, v147, v6 quad_perm:[1,0,3,2] row_mask:0xf bank_mask:0xf
    v_fma_mix_f32 v163, v163, v243, 0 op_sel:[0,1,0] op_sel_hi:[0,1,0]
    s_nop 0
    v_fma_mix_f32 v147, v147, v243, v163 op_sel:[0,0,0] op_sel_hi:[0,1,0]
    v_mul_f32_dpp v164, v148, v6 quad_perm:[1,0,3,2] row_mask:0xf bank_mask:0xf
    v_fma_mix_f32 v164, v164, v244, 0 op_sel:[0,1,0] op_sel_hi:[0,1,0]
    s_nop 0
    v_fma_mix_f32 v148, v148, v244, v164 op_sel:[0,0,0] op_sel_hi:[0,1,0]
    v_mul_f32_dpp v165, v149, v6 quad_perm:[1,0,3,2] row_mask:0xf bank_mask:0xf
    v_fma_mix_f32 v165, v165, v245, 0 op_sel:[0,1,0] op_sel_hi:[0,1,0]
    s_nop 0
    v_fma_mix_f32 v149, v149, v245, v165 op_sel:[0,0,0] op_sel_hi:[0,1,0]
    v_mul_f32_dpp v166, v150, v6 quad_perm:[1,0,3,2] row_mask:0xf bank_mask:0xf
    v_fma_mix_f32 v166, v166, v246, 0 op_sel:[0,1,0] op_sel_hi:[0,1,0]
    s_nop 0
    v_fma_mix_f32 v150, v150, v246, v166 op_sel:[0,0,0] op_sel_hi:[0,1,0]
    v_mul_f32_dpp v167, v151, v6 quad_perm:[1,0,3,2] row_mask:0xf bank_mask:0xf
    v_fma_mix_f32 v167, v167, v247, 0 op_sel:[0,1,0] op_sel_hi:[0,1,0]
    s_nop 0
    v_fma_mix_f32 v151, v151, v247, v167 op_sel:[0,0,0] op_sel_hi:[0,1,0]
    v_mul_f32_dpp v168, v152, v6 quad_perm:[1,0,3,2] row_mask:0xf bank_mask:0xf
    v_fma_mix_f32 v168, v168, v248, 0 op_sel:[0,1,0] op_sel_hi:[0,1,0]
    s_nop 0
    v_fma_mix_f32 v152, v152, v248, v168 op_sel:[0,0,0] op_sel_hi:[0,1,0]
    v_mul_f32_dpp v169, v153, v6 quad_perm:[1,0,3,2] row_mask:0xf bank_mask:0xf
    v_fma_mix_f32 v169, v169, v249, 0 op_sel:[0,1,0] op_sel_hi:[0,1,0]
    s_nop 0
    v_fma_mix_f32 v153, v153, v249, v169 op_sel:[0,0,0] op_sel_hi:[0,1,0]
    v_mul_f32_dpp v170, v154, v6 quad_perm:[1,0,3,2] row_mask:0xf bank_mask:0xf
    v_fma_mix_f32 v170, v170, v250, 0 op_sel:[0,1,0] op_sel_hi:[0,1,0]
    s_nop 0
    v_fma_mix_f32 v154, v154, v250, v170 op_sel:[0,0,0] op_sel_hi:[0,1,0]
    v_mul_f32_dpp v171, v155, v6 quad_perm:[1,0,3,2] row_mask:0xf bank_mask:0xf
    v_fma_mix_f32 v171, v171, v251, 0 op_sel:[0,1,0] op_sel_hi:[0,1,0]
    s_nop 0
    v_fma_mix_f32 v155, v155, v251, v171 op_sel:[0,0,0] op_sel_hi:[0,1,0]
    v_mul_f32_dpp v172, v156, v6 quad_perm:[1,0,3,2] row_mask:0xf bank_mask:0xf
    v_fma_mix_f32 v172, v172, v252, 0 op_sel:[0,1,0] op_sel_hi:[0,1,0]
    s_nop 0
    v_fma_mix_f32 v156, v156, v252, v172 op_sel:[0,0,0] op_sel_hi:[0,1,0]
    v_mul_f32_dpp v173, v157, v6 quad_perm:[1,0,3,2] row_mask:0xf bank_mask:0xf
    v_fma_mix_f32 v173, v173, v253, 0 op_sel:[0,1,0] op_sel_hi:[0,1,0]
    s_nop 0
    v_fma_mix_f32 v157, v157, v253, v173 op_sel:[0,0,0] op_sel_hi:[0,1,0]
    v_mul_f32_dpp v174, v158, v6 quad_perm:[1,0,3,2] row_mask:0xf bank_mask:0xf
    v_fma_mix_f32 v174, v174, v254, 0 op_sel:[0,1,0] op_sel_hi:[0,1,0]
    s_nop 0
    v_fma_mix_f32 v158, v158, v254, v174 op_sel:[0,0,0] op_sel_hi:[0,1,0]
    v_mul_f32_dpp v175, v159, v6 quad_perm:[1,0,3,2] row_mask:0xf bank_mask:0xf
    v_fma_mix_f32 v175, v175, v255, 0 op_sel:[0,1,0] op_sel_hi:[0,1,0]
    s_nop 0
    v_fma_mix_f32 v159, v159, v255, v175 op_sel:[0,0,0] op_sel_hi:[0,1,0]
    v_cvt_pk_f16_f32 v208, v144, v145
    v_cvt_pk_f16_f32 v209, v146, v147
    v_cvt_pk_f16_f32 v210, v148, v149
    v_cvt_pk_f16_f32 v211, v150, v151
    v_cvt_pk_f16_f32 v212, v152, v153
    v_cvt_pk_f16_f32 v213, v154, v155
    v_cvt_pk_f16_f32 v214, v156, v157
    v_cvt_pk_f16_f32 v215, v158, v159
    v_mov_b32 v176, 0
    v_mov_b32 v177, 0
    v_mov_b32 v178, 0
    v_mov_b32 v179, 0
    v_mov_b32 v180, 0
    v_mov_b32 v181, 0
    v_mov_b32 v182, 0
    v_mov_b32 v183, 0
    v_mov_b32 v184, 0
    v_mov_b32 v185, 0
    v_mov_b32 v186, 0
    v_mov_b32 v187, 0
    v_mov_b32 v188, 0
    v_mov_b32 v189, 0
    v_mov_b32 v190, 0
    v_mov_b32 v191, 0
    v_mov_b32 v192, 0
    v_mov_b32 v193, 0
    v_mov_b32 v194, 0
    v_mov_b32 v195, 0
    v_mov_b32 v196, 0
    v_mov_b32 v197, 0
    v_mov_b32 v198, 0
    v_mov_b32 v199, 0
    v_mov_b32 v200, 0
    v_mov_b32 v201, 0
    v_mov_b32 v202, 0
    v_mov_b32 v203, 0
    v_mov_b32 v204, 0
    v_mov_b32 v205, 0
    v_mov_b32 v206, 0
    v_mov_b32 v207, 0
    v_mfma_f32_32x32x16_f16 v[176:191], v[64:67], v[112:115], v[176:191]
    v_mfma_f32_32x32x16_f16 v[176:191], v[68:71], v[116:119], v[176:191]
    v_mfma_f32_32x32x16_f16 v[176:191], v[72:75], v[120:123], v[176:191]
    v_mfma_f32_32x32x16_f16 v[176:191], v[76:79], v[124:127], v[176:191]
    v_mfma_f32_32x32x16_f16 v[192:207], v[96:99], v[112:115], v[192:207]
    v_mfma_f32_32x32x16_f16 v[192:207], v[100:103], v[116:119], v[192:207]
    v_mfma_f32_32x32x16_f16 v[192:207], v[104:107], v[120:123], v[192:207]
    v_mfma_f32_32x32x16_f16 v[192:207], v[108:111], v[124:127], v[192:207]
    ds_read_b128 v[240:243], v8 offset:2048
    ds_read_b128 v[244:247], v8 offset:2560
    ds_read_b128 v[248:251], v8 offset:3072
    ds_read_b128 v[252:255], v8 offset:3584
    s_nop 7
    v_fmac_f32_dpp v176, v192, v5 quad_perm:[1,0,3,2] row_mask:0xf bank_mask:0xf
    v_fmac_f32_dpp v177, v193, v5 quad_perm:[1,0,3,2] row_mask:0xf bank_mask:0xf
    v_fmac_f32_dpp v178, v194, v5 quad_perm:[1,0,3,2] row_mask:0xf bank_mask:0xf
    v_fmac_f32_dpp v179, v195, v5 quad_perm:[1,0,3,2] row_mask:0xf bank_mask:0xf
    v_fmac_f32_dpp v180, v196, v5 quad_perm:[1,0,3,2] row_mask:0xf bank_mask:0xf
    v_fmac_f32_dpp v181, v197, v5 quad_perm:[1,0,3,2] row_mask:0xf bank_mask:0xf
    v_fmac_f32_dpp v182, v198, v5 quad_perm:[1,0,3,2] row_mask:0xf bank_mask:0xf
    v_fmac_f32_dpp v183, v199, v5 quad_perm:[1,0,3,2] row_mask:0xf bank_mask:0xf
    v_fmac_f32_dpp v184, v200, v5 quad_perm:[1,0,3,2] row_mask:0xf bank_mask:0xf
    v_fmac_f32_dpp v185, v201, v5 quad_perm:[1,0,3,2] row_mask:0xf bank_mask:0xf
    v_fmac_f32_dpp v186, v202, v5 quad_perm:[1,0,3,2] row_mask:0xf bank_mask:0xf
    v_fmac_f32_dpp v187, v203, v5 quad_perm:[1,0,3,2] row_mask:0xf bank_mask:0xf
    v_fmac_f32_dpp v188, v204, v5 quad_perm:[1,0,3,2] row_mask:0xf bank_mask:0xf
    v_fmac_f32_dpp v189, v205, v5 quad_perm:[1,0,3,2] row_mask:0xf bank_mask:0xf
    v_fmac_f32_dpp v190, v206, v5 quad_perm:[1,0,3,2] row_mask:0xf bank_mask:0xf
    v_fmac_f32_dpp v191, v207, v5 quad_perm:[1,0,3,2] row_mask:0xf bank_mask:0xf
    s_waitcnt lgkmcnt(0)
    v_mul_f32_dpp v192, v176, v6 quad_perm:[1,0,3,2] row_mask:0xf bank_mask:0xf
    v_fma_mix_f32 v192, v192, v240, 0 op_sel:[0,1,0] op_sel_hi:[0,1,0]
    s_nop 0
    v_fma_mix_f32 v176, v176, v240, v192 op_sel:[0,0,0] op_sel_hi:[0,1,0]
    v_mul_f32_dpp v193, v177, v6 quad_perm:[1,0,3,2] row_mask:0xf bank_mask:0xf
    v_fma_mix_f32 v193, v193, v241, 0 op_sel:[0,1,0] op_sel_hi:[0,1,0]
    s_nop 0
    v_fma_mix_f32 v177, v177, v241, v193 op_sel:[0,0,0] op_sel_hi:[0,1,0]
    v_mul_f32_dpp v194, v178, v6 quad_perm:[1,0,3,2] row_mask:0xf bank_mask:0xf
    v_fma_mix_f32 v194, v194, v242, 0 op_sel:[0,1,0] op_sel_hi:[0,1,0]
    s_nop 0
    v_fma_mix_f32 v178, v178, v242, v194 op_sel:[0,0,0] op_sel_hi:[0,1,0]
    v_mul_f32_dpp v195, v179, v6 quad_perm:[1,0,3,2] row_mask:0xf bank_mask:0xf
    v_fma_mix_f32 v195, v195, v243, 0 op_sel:[0,1,0] op_sel_hi:[0,1,0]
    s_nop 0
    v_fma_mix_f32 v179, v179, v243, v195 op_sel:[0,0,0] op_sel_hi:[0,1,0]
    v_mul_f32_dpp v196, v180, v6 quad_perm:[1,0,3,2] row_mask:0xf bank_mask:0xf
    v_fma_mix_f32 v196, v196, v244, 0 op_sel:[0,1,0] op_sel_hi:[0,1,0]
    s_nop 0
    v_fma_mix_f32 v180, v180, v244, v196 op_sel:[0,0,0] op_sel_hi:[0,1,0]
    v_mul_f32_dpp v197, v181, v6 quad_perm:[1,0,3,2] row_mask:0xf bank_mask:0xf
    v_fma_mix_f32 v197, v197, v245, 0 op_sel:[0,1,0] op_sel_hi:[0,1,0]
    s_nop 0
    v_fma_mix_f32 v181, v181, v245, v197 op_sel:[0,0,0] op_sel_hi:[0,1,0]
    v_mul_f32_dpp v198, v182, v6 quad_perm:[1,0,3,2] row_mask:0xf bank_mask:0xf
    v_fma_mix_f32 v198, v198, v246, 0 op_sel:[0,1,0] op_sel_hi:[0,1,0]
    s_nop 0
    v_fma_mix_f32 v182, v182, v246, v198 op_sel:[0,0,0] op_sel_hi:[0,1,0]
    v_mul_f32_dpp v199, v183, v6 quad_perm:[1,0,3,2] row_mask:0xf bank_mask:0xf
    v_fma_mix_f32 v199, v199, v247, 0 op_sel:[0,1,0] op_sel_hi:[0,1,0]
    s_nop 0
    v_fma_mix_f32 v183, v183, v247, v199 op_sel:[0,0,0] op_sel_hi:[0,1,0]
    v_mul_f32_dpp v200, v184, v6 quad_perm:[1,0,3,2] row_mask:0xf bank_mask:0xf
    v_fma_mix_f32 v200, v200, v248, 0 op_sel:[0,1,0] op_sel_hi:[0,1,0]
    s_nop 0
    v_fma_mix_f32 v184, v184, v248, v200 op_sel:[0,0,0] op_sel_hi:[0,1,0]
    v_mul_f32_dpp v201, v185, v6 quad_perm:[1,0,3,2] row_mask:0xf bank_mask:0xf
    v_fma_mix_f32 v201, v201, v249, 0 op_sel:[0,1,0] op_sel_hi:[0,1,0]
    s_nop 0
    v_fma_mix_f32 v185, v185, v249, v201 op_sel:[0,0,0] op_sel_hi:[0,1,0]
    v_mul_f32_dpp v202, v186, v6 quad_perm:[1,0,3,2] row_mask:0xf bank_mask:0xf
    v_fma_mix_f32 v202, v202, v250, 0 op_sel:[0,1,0] op_sel_hi:[0,1,0]
    s_nop 0
    v_fma_mix_f32 v186, v186, v250, v202 op_sel:[0,0,0] op_sel_hi:[0,1,0]
    v_mul_f32_dpp v203, v187, v6 quad_perm:[1,0,3,2] row_mask:0xf bank_mask:0xf
    v_fma_mix_f32 v203, v203, v251, 0 op_sel:[0,1,0] op_sel_hi:[0,1,0]
    s_nop 0
    v_fma_mix_f32 v187, v187, v251, v203 op_sel:[0,0,0] op_sel_hi:[0,1,0]
    v_mul_f32_dpp v204, v188, v6 quad_perm:[1,0,3,2] row_mask:0xf bank_mask:0xf
    v_fma_mix_f32 v204, v204, v252, 0 op_sel:[0,1,0] op_sel_hi:[0,1,0]
    s_nop 0
    v_fma_mix_f32 v188, v188, v252, v204 op_sel:[0,0,0] op_sel_hi:[0,1,0]
    v_mul_f32_dpp v205, v189, v6 quad_perm:[1,0,3,2] row_mask:0xf bank_mask:0xf
    v_fma_mix_f32 v205, v205, v253, 0 op_sel:[0,1,0] op_sel_hi:[0,1,0]
    s_nop 0
    v_fma_mix_f32 v189, v189, v253, v205 op_sel:[0,0,0] op_sel_hi:[0,1,0]
    v_mul_f32_dpp v206, v190, v6 quad_perm:[1,0,3,2] row_mask:0xf bank_mask:0xf
    v_fma_mix_f32 v206, v206, v254, 0 op_sel:[0,1,0] op_sel_hi:[0,1,0]
    s_nop 0
    v_fma_mix_f32 v190, v190, v254, v206 op_sel:[0,0,0] op_sel_hi:[0,1,0]
    v_mul_f32_dpp v207, v191, v6 quad_perm:[1,0,3,2] row_mask:0xf bank_mask:0xf
    v_fma_mix_f32 v207, v207, v255, 0 op_sel:[0,1,0] op_sel_hi:[0,1,0]
    s_nop 0
    v_fma_mix_f32 v191, v191, v255, v207 op_sel:[0,0,0] op_sel_hi:[0,1,0]
    v_cvt_pk_f16_f32 v216, v176, v177
    v_cvt_pk_f16_f32 v217, v178, v179
    v_cvt_pk_f16_f32 v218, v180, v181
    v_cvt_pk_f16_f32 v219, v182, v183
    v_cvt_pk_f16_f32 v220, v184, v185
    v_cvt_pk_f16_f32 v221, v186, v187
    v_cvt_pk_f16_f32 v222, v188, v189
    v_cvt_pk_f16_f32 v223, v190, v191
    v_mov_b32 v144, 0
    v_mov_b32 v145, 0
    v_mov_b32 v146, 0
    v_mov_b32 v147, 0
    v_mov_b32 v148, 0
    v_mov_b32 v149, 0
    v_mov_b32 v150, 0
    v_mov_b32 v151, 0
    v_mov_b32 v152, 0
    v_mov_b32 v153, 0
    v_mov_b32 v154, 0
    v_mov_b32 v155, 0
    v_mov_b32 v156, 0
    v_mov_b32 v157, 0
    v_mov_b32 v158, 0
    v_mov_b32 v159, 0
    v_mov_b32 v160, 0
    v_mov_b32 v161, 0
    v_mov_b32 v162, 0
    v_mov_b32 v163, 0
    v_mov_b32 v164, 0
    v_mov_b32 v165, 0
    v_mov_b32 v166, 0
    v_mov_b32 v167, 0
    v_mov_b32 v168, 0
    v_mov_b32 v169, 0
    v_mov_b32 v170, 0
    v_mov_b32 v171, 0
    v_mov_b32 v172, 0
    v_mov_b32 v173, 0
    v_mov_b32 v174, 0
    v_mov_b32 v175, 0
    v_mfma_f32_32x32x16_f16 v[144:159], v[48:51], v[128:131], v[144:159]
    v_mfma_f32_32x32x16_f16 v[144:159], v[52:55], v[132:135], v[144:159]
    v_mfma_f32_32x32x16_f16 v[144:159], v[56:59], v[136:139], v[144:159]
    v_mfma_f32_32x32x16_f16 v[144:159], v[60:63], v[140:143], v[144:159]
    v_mfma_f32_32x32x16_f16 v[160:175], v[80:83], v[128:131], v[160:175]
    v_mfma_f32_32x32x16_f16 v[160:175], v[84:87], v[132:135], v[160:175]
    v_mfma_f32_32x32x16_f16 v[160:175], v[88:91], v[136:139], v[160:175]
    v_mfma_f32_32x32x16_f16 v[160:175], v[92:95], v[140:143], v[160:175]
    ds_read_b128 v[240:243], v8 offset:4096
    ds_read_b128 v[244:247], v8 offset:4608
    ds_read_b128 v[248:251], v8 offset:5120
    ds_read_b128 v[252:255], v8 offset:5632
    s_nop 7
    v_fmac_f32_dpp v144, v160, v5 quad_perm:[1,0,3,2] row_mask:0xf bank_mask:0xf
    v_fmac_f32_dpp v145, v161, v5 quad_perm:[1,0,3,2] row_mask:0xf bank_mask:0xf
    v_fmac_f32_dpp v146, v162, v5 quad_perm:[1,0,3,2] row_mask:0xf bank_mask:0xf
    v_fmac_f32_dpp v147, v163, v5 quad_perm:[1,0,3,2] row_mask:0xf bank_mask:0xf
    v_fmac_f32_dpp v148, v164, v5 quad_perm:[1,0,3,2] row_mask:0xf bank_mask:0xf
    v_fmac_f32_dpp v149, v165, v5 quad_perm:[1,0,3,2] row_mask:0xf bank_mask:0xf
    v_fmac_f32_dpp v150, v166, v5 quad_perm:[1,0,3,2] row_mask:0xf bank_mask:0xf
    v_fmac_f32_dpp v151, v167, v5 quad_perm:[1,0,3,2] row_mask:0xf bank_mask:0xf
    v_fmac_f32_dpp v152, v168, v5 quad_perm:[1,0,3,2] row_mask:0xf bank_mask:0xf
    v_fmac_f32_dpp v153, v169, v5 quad_perm:[1,0,3,2] row_mask:0xf bank_mask:0xf
    v_fmac_f32_dpp v154, v170, v5 quad_perm:[1,0,3,2] row_mask:0xf bank_mask:0xf
    v_fmac_f32_dpp v155, v171, v5 quad_perm:[1,0,3,2] row_mask:0xf bank_mask:0xf
    v_fmac_f32_dpp v156, v172, v5 quad_perm:[1,0,3,2] row_mask:0xf bank_mask:0xf
    v_fmac_f32_dpp v157, v173, v5 quad_perm:[1,0,3,2] row_mask:0xf bank_mask:0xf
    v_fmac_f32_dpp v158, v174, v5 quad_perm:[1,0,3,2] row_mask:0xf bank_mask:0xf
    v_fmac_f32_dpp v159, v175, v5 quad_perm:[1,0,3,2] row_mask:0xf bank_mask:0xf
    s_waitcnt lgkmcnt(0)
    v_mul_f32_dpp v160, v144, v6 quad_perm:[1,0,3,2] row_mask:0xf bank_mask:0xf
    v_fma_mix_f32 v160, v160, v240, 0 op_sel:[0,1,0] op_sel_hi:[0,1,0]
    s_nop 0
    v_fma_mix_f32 v144, v144, v240, v160 op_sel:[0,0,0] op_sel_hi:[0,1,0]
    v_mul_f32_dpp v161, v145, v6 quad_perm:[1,0,3,2] row_mask:0xf bank_mask:0xf
    v_fma_mix_f32 v161, v161, v241, 0 op_sel:[0,1,0] op_sel_hi:[0,1,0]
    s_nop 0
    v_fma_mix_f32 v145, v145, v241, v161 op_sel:[0,0,0] op_sel_hi:[0,1,0]
    v_mul_f32_dpp v162, v146, v6 quad_perm:[1,0,3,2] row_mask:0xf bank_mask:0xf
    v_fma_mix_f32 v162, v162, v242, 0 op_sel:[0,1,0] op_sel_hi:[0,1,0]
    s_nop 0
    v_fma_mix_f32 v146, v146, v242, v162 op_sel:[0,0,0] op_sel_hi:[0,1,0]
    v_mul_f32_dpp v163, v147, v6 quad_perm:[1,0,3,2] row_mask:0xf bank_mask:0xf
    v_fma_mix_f32 v163, v163, v243, 0 op_sel:[0,1,0] op_sel_hi:[0,1,0]
    s_nop 0
    v_fma_mix_f32 v147, v147, v243, v163 op_sel:[0,0,0] op_sel_hi:[0,1,0]
    v_mul_f32_dpp v164, v148, v6 quad_perm:[1,0,3,2] row_mask:0xf bank_mask:0xf
    v_fma_mix_f32 v164, v164, v244, 0 op_sel:[0,1,0] op_sel_hi:[0,1,0]
    s_nop 0
    v_fma_mix_f32 v148, v148, v244, v164 op_sel:[0,0,0] op_sel_hi:[0,1,0]
    v_mul_f32_dpp v165, v149, v6 quad_perm:[1,0,3,2] row_mask:0xf bank_mask:0xf
    v_fma_mix_f32 v165, v165, v245, 0 op_sel:[0,1,0] op_sel_hi:[0,1,0]
    s_nop 0
    v_fma_mix_f32 v149, v149, v245, v165 op_sel:[0,0,0] op_sel_hi:[0,1,0]
    v_mul_f32_dpp v166, v150, v6 quad_perm:[1,0,3,2] row_mask:0xf bank_mask:0xf
    v_fma_mix_f32 v166, v166, v246, 0 op_sel:[0,1,0] op_sel_hi:[0,1,0]
    s_nop 0
    v_fma_mix_f32 v150, v150, v246, v166 op_sel:[0,0,0] op_sel_hi:[0,1,0]
    v_mul_f32_dpp v167, v151, v6 quad_perm:[1,0,3,2] row_mask:0xf bank_mask:0xf
    v_fma_mix_f32 v167, v167, v247, 0 op_sel:[0,1,0] op_sel_hi:[0,1,0]
    s_nop 0
    v_fma_mix_f32 v151, v151, v247, v167 op_sel:[0,0,0] op_sel_hi:[0,1,0]
    v_mul_f32_dpp v168, v152, v6 quad_perm:[1,0,3,2] row_mask:0xf bank_mask:0xf
    v_fma_mix_f32 v168, v168, v248, 0 op_sel:[0,1,0] op_sel_hi:[0,1,0]
    s_nop 0
    v_fma_mix_f32 v152, v152, v248, v168 op_sel:[0,0,0] op_sel_hi:[0,1,0]
    v_mul_f32_dpp v169, v153, v6 quad_perm:[1,0,3,2] row_mask:0xf bank_mask:0xf
    v_fma_mix_f32 v169, v169, v249, 0 op_sel:[0,1,0] op_sel_hi:[0,1,0]
    s_nop 0
    v_fma_mix_f32 v153, v153, v249, v169 op_sel:[0,0,0] op_sel_hi:[0,1,0]
    v_mul_f32_dpp v170, v154, v6 quad_perm:[1,0,3,2] row_mask:0xf bank_mask:0xf
    v_fma_mix_f32 v170, v170, v250, 0 op_sel:[0,1,0] op_sel_hi:[0,1,0]
    s_nop 0
    v_fma_mix_f32 v154, v154, v250, v170 op_sel:[0,0,0] op_sel_hi:[0,1,0]
    v_mul_f32_dpp v171, v155, v6 quad_perm:[1,0,3,2] row_mask:0xf bank_mask:0xf
    v_fma_mix_f32 v171, v171, v251, 0 op_sel:[0,1,0] op_sel_hi:[0,1,0]
    s_nop 0
    v_fma_mix_f32 v155, v155, v251, v171 op_sel:[0,0,0] op_sel_hi:[0,1,0]
    v_mul_f32_dpp v172, v156, v6 quad_perm:[1,0,3,2] row_mask:0xf bank_mask:0xf
    v_fma_mix_f32 v172, v172, v252, 0 op_sel:[0,1,0] op_sel_hi:[0,1,0]
    s_nop 0
    v_fma_mix_f32 v156, v156, v252, v172 op_sel:[0,0,0] op_sel_hi:[0,1,0]
    v_mul_f32_dpp v173, v157, v6 quad_perm:[1,0,3,2] row_mask:0xf bank_mask:0xf
    v_fma_mix_f32 v173, v173, v253, 0 op_sel:[0,1,0] op_sel_hi:[0,1,0]
    s_nop 0
    v_fma_mix_f32 v157, v157, v253, v173 op_sel:[0,0,0] op_sel_hi:[0,1,0]
    v_mul_f32_dpp v174, v158, v6 quad_perm:[1,0,3,2] row_mask:0xf bank_mask:0xf
    v_fma_mix_f32 v174, v174, v254, 0 op_sel:[0,1,0] op_sel_hi:[0,1,0]
    s_nop 0
    v_fma_mix_f32 v158, v158, v254, v174 op_sel:[0,0,0] op_sel_hi:[0,1,0]
    v_mul_f32_dpp v175, v159, v6 quad_perm:[1,0,3,2] row_mask:0xf bank_mask:0xf
    v_fma_mix_f32 v175, v175, v255, 0 op_sel:[0,1,0] op_sel_hi:[0,1,0]
    s_nop 0
    v_fma_mix_f32 v159, v159, v255, v175 op_sel:[0,0,0] op_sel_hi:[0,1,0]
    v_cvt_pk_f16_f32 v224, v144, v145
    v_cvt_pk_f16_f32 v225, v146, v147
    v_cvt_pk_f16_f32 v226, v148, v149
    v_cvt_pk_f16_f32 v227, v150, v151
    v_cvt_pk_f16_f32 v228, v152, v153
    v_cvt_pk_f16_f32 v229, v154, v155
    v_cvt_pk_f16_f32 v230, v156, v157
    v_cvt_pk_f16_f32 v231, v158, v159
    v_mov_b32 v176, 0
    v_mov_b32 v177, 0
    v_mov_b32 v178, 0
    v_mov_b32 v179, 0
    v_mov_b32 v180, 0
    v_mov_b32 v181, 0
    v_mov_b32 v182, 0
    v_mov_b32 v183, 0
    v_mov_b32 v184, 0
    v_mov_b32 v185, 0
    v_mov_b32 v186, 0
    v_mov_b32 v187, 0
    v_mov_b32 v188, 0
    v_mov_b32 v189, 0
    v_mov_b32 v190, 0
    v_mov_b32 v191, 0
    v_mov_b32 v192, 0
    v_mov_b32 v193, 0
    v_mov_b32 v194, 0
    v_mov_b32 v195, 0
    v_mov_b32 v196, 0
    v_mov_b32 v197, 0
    v_mov_b32 v198, 0
    v_mov_b32 v199, 0
    v_mov_b32 v200, 0
    v_mov_b32 v201, 0
    v_mov_b32 v202, 0
    v_mov_b32 v203, 0
    v_mov_b32 v204, 0
    v_mov_b32 v205, 0
    v_mov_b32 v206, 0
    v_mov_b32 v207, 0
    v_mfma_f32_32x32x16_f16 v[176:191], v[64:67], v[128:131], v[176:191]
    v_mfma_f32_32x32x16_f16 v[176:191], v[68:71], v[132:135], v[176:191]
    v_mfma_f32_32x32x16_f16 v[176:191], v[72:75], v[136:139], v[176:191]
    v_mfma_f32_32x32x16_f16 v[176:191], v[76:79], v[140:143], v[176:191]
    v_mfma_f32_32x32x16_f16 v[192:207], v[96:99], v[128:131], v[192:207]
    v_mfma_f32_32x32x16_f16 v[192:207], v[100:103], v[132:135], v[192:207]
    v_mfma_f32_32x32x16_f16 v[192:207], v[104:107], v[136:139], v[192:207]
    v_mfma_f32_32x32x16_f16 v[192:207], v[108:111], v[140:143], v[192:207]
    ds_read_b128 v[240:243], v8 offset:6144
    ds_read_b128 v[244:247], v8 offset:6656
    ds_read_b128 v[248:251], v8 offset:7168
    ds_read_b128 v[252:255], v8 offset:7680
    s_nop 7
    v_fmac_f32_dpp v176, v192, v5 quad_perm:[1,0,3,2] row_mask:0xf bank_mask:0xf
    v_fmac_f32_dpp v177, v193, v5 quad_perm:[1,0,3,2] row_mask:0xf bank_mask:0xf
    v_fmac_f32_dpp v178, v194, v5 quad_perm:[1,0,3,2] row_mask:0xf bank_mask:0xf
    v_fmac_f32_dpp v179, v195, v5 quad_perm:[1,0,3,2] row_mask:0xf bank_mask:0xf
    v_fmac_f32_dpp v180, v196, v5 quad_perm:[1,0,3,2] row_mask:0xf bank_mask:0xf
    v_fmac_f32_dpp v181, v197, v5 quad_perm:[1,0,3,2] row_mask:0xf bank_mask:0xf
    v_fmac_f32_dpp v182, v198, v5 quad_perm:[1,0,3,2] row_mask:0xf bank_mask:0xf
    v_fmac_f32_dpp v183, v199, v5 quad_perm:[1,0,3,2] row_mask:0xf bank_mask:0xf
    v_fmac_f32_dpp v184, v200, v5 quad_perm:[1,0,3,2] row_mask:0xf bank_mask:0xf
    v_fmac_f32_dpp v185, v201, v5 quad_perm:[1,0,3,2] row_mask:0xf bank_mask:0xf
    v_fmac_f32_dpp v186, v202, v5 quad_perm:[1,0,3,2] row_mask:0xf bank_mask:0xf
    v_fmac_f32_dpp v187, v203, v5 quad_perm:[1,0,3,2] row_mask:0xf bank_mask:0xf
    v_fmac_f32_dpp v188, v204, v5 quad_perm:[1,0,3,2] row_mask:0xf bank_mask:0xf
    v_fmac_f32_dpp v189, v205, v5 quad_perm:[1,0,3,2] row_mask:0xf bank_mask:0xf
    v_fmac_f32_dpp v190, v206, v5 quad_perm:[1,0,3,2] row_mask:0xf bank_mask:0xf
    v_fmac_f32_dpp v191, v207, v5 quad_perm:[1,0,3,2] row_mask:0xf bank_mask:0xf
    s_waitcnt lgkmcnt(0)
    v_mul_f32_dpp v192, v176, v6 quad_perm:[1,0,3,2] row_mask:0xf bank_mask:0xf
    v_fma_mix_f32 v192, v192, v240, 0 op_sel:[0,1,0] op_sel_hi:[0,1,0]
    s_nop 0
    v_fma_mix_f32 v176, v176, v240, v192 op_sel:[0,0,0] op_sel_hi:[0,1,0]
    v_mul_f32_dpp v193, v177, v6 quad_perm:[1,0,3,2] row_mask:0xf bank_mask:0xf
    v_fma_mix_f32 v193, v193, v241, 0 op_sel:[0,1,0] op_sel_hi:[0,1,0]
    s_nop 0
    v_fma_mix_f32 v177, v177, v241, v193 op_sel:[0,0,0] op_sel_hi:[0,1,0]
    v_mul_f32_dpp v194, v178, v6 quad_perm:[1,0,3,2] row_mask:0xf bank_mask:0xf
    v_fma_mix_f32 v194, v194, v242, 0 op_sel:[0,1,0] op_sel_hi:[0,1,0]
    s_nop 0
    v_fma_mix_f32 v178, v178, v242, v194 op_sel:[0,0,0] op_sel_hi:[0,1,0]
    v_mul_f32_dpp v195, v179, v6 quad_perm:[1,0,3,2] row_mask:0xf bank_mask:0xf
    v_fma_mix_f32 v195, v195, v243, 0 op_sel:[0,1,0] op_sel_hi:[0,1,0]
    s_nop 0
    v_fma_mix_f32 v179, v179, v243, v195 op_sel:[0,0,0] op_sel_hi:[0,1,0]
    v_mul_f32_dpp v196, v180, v6 quad_perm:[1,0,3,2] row_mask:0xf bank_mask:0xf
    v_fma_mix_f32 v196, v196, v244, 0 op_sel:[0,1,0] op_sel_hi:[0,1,0]
    s_nop 0
    v_fma_mix_f32 v180, v180, v244, v196 op_sel:[0,0,0] op_sel_hi:[0,1,0]
    v_mul_f32_dpp v197, v181, v6 quad_perm:[1,0,3,2] row_mask:0xf bank_mask:0xf
    v_fma_mix_f32 v197, v197, v245, 0 op_sel:[0,1,0] op_sel_hi:[0,1,0]
    s_nop 0
    v_fma_mix_f32 v181, v181, v245, v197 op_sel:[0,0,0] op_sel_hi:[0,1,0]
    v_mul_f32_dpp v198, v182, v6 quad_perm:[1,0,3,2] row_mask:0xf bank_mask:0xf
    v_fma_mix_f32 v198, v198, v246, 0 op_sel:[0,1,0] op_sel_hi:[0,1,0]
    s_nop 0
    v_fma_mix_f32 v182, v182, v246, v198 op_sel:[0,0,0] op_sel_hi:[0,1,0]
    v_mul_f32_dpp v199, v183, v6 quad_perm:[1,0,3,2] row_mask:0xf bank_mask:0xf
    v_fma_mix_f32 v199, v199, v247, 0 op_sel:[0,1,0] op_sel_hi:[0,1,0]
    s_nop 0
    v_fma_mix_f32 v183, v183, v247, v199 op_sel:[0,0,0] op_sel_hi:[0,1,0]
    v_mul_f32_dpp v200, v184, v6 quad_perm:[1,0,3,2] row_mask:0xf bank_mask:0xf
    v_fma_mix_f32 v200, v200, v248, 0 op_sel:[0,1,0] op_sel_hi:[0,1,0]
    s_nop 0
    v_fma_mix_f32 v184, v184, v248, v200 op_sel:[0,0,0] op_sel_hi:[0,1,0]
    v_mul_f32_dpp v201, v185, v6 quad_perm:[1,0,3,2] row_mask:0xf bank_mask:0xf
    v_fma_mix_f32 v201, v201, v249, 0 op_sel:[0,1,0] op_sel_hi:[0,1,0]
    s_nop 0
    v_fma_mix_f32 v185, v185, v249, v201 op_sel:[0,0,0] op_sel_hi:[0,1,0]
    v_mul_f32_dpp v202, v186, v6 quad_perm:[1,0,3,2] row_mask:0xf bank_mask:0xf
    v_fma_mix_f32 v202, v202, v250, 0 op_sel:[0,1,0] op_sel_hi:[0,1,0]
    s_nop 0
    v_fma_mix_f32 v186, v186, v250, v202 op_sel:[0,0,0] op_sel_hi:[0,1,0]
    v_mul_f32_dpp v203, v187, v6 quad_perm:[1,0,3,2] row_mask:0xf bank_mask:0xf
    v_fma_mix_f32 v203, v203, v251, 0 op_sel:[0,1,0] op_sel_hi:[0,1,0]
    s_nop 0
    v_fma_mix_f32 v187, v187, v251, v203 op_sel:[0,0,0] op_sel_hi:[0,1,0]
    v_mul_f32_dpp v204, v188, v6 quad_perm:[1,0,3,2] row_mask:0xf bank_mask:0xf
    v_fma_mix_f32 v204, v204, v252, 0 op_sel:[0,1,0] op_sel_hi:[0,1,0]
    s_nop 0
    v_fma_mix_f32 v188, v188, v252, v204 op_sel:[0,0,0] op_sel_hi:[0,1,0]
    v_mul_f32_dpp v205, v189, v6 quad_perm:[1,0,3,2] row_mask:0xf bank_mask:0xf
    v_fma_mix_f32 v205, v205, v253, 0 op_sel:[0,1,0] op_sel_hi:[0,1,0]
    s_nop 0
    v_fma_mix_f32 v189, v189, v253, v205 op_sel:[0,0,0] op_sel_hi:[0,1,0]
    v_mul_f32_dpp v206, v190, v6 quad_perm:[1,0,3,2] row_mask:0xf bank_mask:0xf
    v_fma_mix_f32 v206, v206, v254, 0 op_sel:[0,1,0] op_sel_hi:[0,1,0]
    s_nop 0
    v_fma_mix_f32 v190, v190, v254, v206 op_sel:[0,0,0] op_sel_hi:[0,1,0]
    v_mul_f32_dpp v207, v191, v6 quad_perm:[1,0,3,2] row_mask:0xf bank_mask:0xf
    v_fma_mix_f32 v207, v207, v255, 0 op_sel:[0,1,0] op_sel_hi:[0,1,0]
    s_nop 0
    v_fma_mix_f32 v191, v191, v255, v207 op_sel:[0,0,0] op_sel_hi:[0,1,0]
    v_cvt_pk_f16_f32 v232, v176, v177
    v_cvt_pk_f16_f32 v233, v178, v179
    v_cvt_pk_f16_f32 v234, v180, v181
    v_cvt_pk_f16_f32 v235, v182, v183
    v_cvt_pk_f16_f32 v236, v184, v185
    v_cvt_pk_f16_f32 v237, v186, v187
    v_cvt_pk_f16_f32 v238, v188, v189
    v_cvt_pk_f16_f32 v239, v190, v191
    v_mov_b32 v144, 0
    v_mov_b32 v145, 0
    v_mov_b32 v146, 0
    v_mov_b32 v147, 0
    v_mov_b32 v148, 0
    v_mov_b32 v149, 0
    v_mov_b32 v150, 0
    v_mov_b32 v151, 0
    v_mov_b32 v152, 0
    v_mov_b32 v153, 0
    v_mov_b32 v154, 0
    v_mov_b32 v155, 0
    v_mov_b32 v156, 0
    v_mov_b32 v157, 0
    v_mov_b32 v158, 0
    v_mov_b32 v159, 0
    v_mov_b32 v160, 0
    v_mov_b32 v161, 0
    v_mov_b32 v162, 0
    v_mov_b32 v163, 0
    v_mov_b32 v164, 0
    v_mov_b32 v165, 0
    v_mov_b32 v166, 0
    v_mov_b32 v167, 0
    v_mov_b32 v168, 0
    v_mov_b32 v169, 0
    v_mov_b32 v170, 0
    v_mov_b32 v171, 0
    v_mov_b32 v172, 0
    v_mov_b32 v173, 0
    v_mov_b32 v174, 0
    v_mov_b32 v175, 0
    v_mfma_f32_32x32x16_f16 v[144:159], v[208:211], v[48:51], v[144:159]
    v_mfma_f32_32x32x16_f16 v[144:159], v[212:215], v[52:55], v[144:159]
    v_mfma_f32_32x32x16_f16 v[144:159], v[216:219], v[56:59], v[144:159]
    v_mfma_f32_32x32x16_f16 v[144:159], v[220:223], v[60:63], v[144:159]
    v_mfma_f32_32x32x16_f16 v[160:175], v[208:211], v[80:83], v[160:175]
    v_mfma_f32_32x32x16_f16 v[160:175], v[212:215], v[84:87], v[160:175]
    v_mfma_f32_32x32x16_f16 v[160:175], v[216:219], v[88:91], v[160:175]
    v_mfma_f32_32x32x16_f16 v[160:175], v[220:223], v[92:95], v[160:175]
    ds_read_b128 v[240:243], v2 offset:32768
    ds_read_b128 v[244:247], v2 offset:33792
    ds_read_b128 v[248:251], v2 offset:34816
    ds_read_b128 v[252:255], v2 offset:35840
    s_nop 7
    v_sub_f32 v144, v144, v161
    v_add_f32 v145, v145, v160
    v_sub_f32 v146, v146, v163
    v_add_f32 v147, v147, v162
    v_sub_f32 v148, v148, v165
    v_add_f32 v149, v149, v164
    v_sub_f32 v150, v150, v167
    v_add_f32 v151, v151, v166
    v_sub_f32 v152, v152, v169
    v_add_f32 v153, v153, v168
    v_sub_f32 v154, v154, v171
    v_add_f32 v155, v155, v170
    v_sub_f32 v156, v156, v173
    v_add_f32 v157, v157, v172
    v_sub_f32 v158, v158, v175
    v_add_f32 v159, v159, v174
    s_waitcnt lgkmcnt(0)
    v_mul_f32 v160, v144, v240
    v_fma_f32 v160, -v145, v241, v160
    v_mul_f32 v161, v144, v241
    v_fmac_f32 v161, v145, v240
    v_cvt_pk_f16_f32 v112, v160, -v161
    v_mul_f32 v162, v146, v242
    v_fma_f32 v162, -v147, v243, v162
    v_mul_f32 v163, v146, v243
    v_fmac_f32 v163, v147, v242
    v_cvt_pk_f16_f32 v113, v162, -v163
    v_mul_f32 v164, v148, v244
    v_fma_f32 v164, -v149, v245, v164
    v_mul_f32 v165, v148, v245
    v_fmac_f32 v165, v149, v244
    v_cvt_pk_f16_f32 v114, v164, -v165
    v_mul_f32 v166, v150, v246
    v_fma_f32 v166, -v151, v247, v166
    v_mul_f32 v167, v150, v247
    v_fmac_f32 v167, v151, v246
    v_cvt_pk_f16_f32 v115, v166, -v167
    v_mul_f32 v168, v152, v248
    v_fma_f32 v168, -v153, v249, v168
    v_mul_f32 v169, v152, v249
    v_fmac_f32 v169, v153, v248
    v_cvt_pk_f16_f32 v116, v168, -v169
    v_mul_f32 v170, v154, v250
    v_fma_f32 v170, -v155, v251, v170
    v_mul_f32 v171, v154, v251
    v_fmac_f32 v171, v155, v250
    v_cvt_pk_f16_f32 v117, v170, -v171
    v_mul_f32 v172, v156, v252
    v_fma_f32 v172, -v157, v253, v172
    v_mul_f32 v173, v156, v253
    v_fmac_f32 v173, v157, v252
    v_cvt_pk_f16_f32 v118, v172, -v173
    v_mul_f32 v174, v158, v254
    v_fma_f32 v174, -v159, v255, v174
    v_mul_f32 v175, v158, v255
    v_fmac_f32 v175, v159, v254
    v_cvt_pk_f16_f32 v119, v174, -v175
    v_mov_b32 v176, 0
    v_mov_b32 v177, 0
    v_mov_b32 v178, 0
    v_mov_b32 v179, 0
    v_mov_b32 v180, 0
    v_mov_b32 v181, 0
    v_mov_b32 v182, 0
    v_mov_b32 v183, 0
    v_mov_b32 v184, 0
    v_mov_b32 v185, 0
    v_mov_b32 v186, 0
    v_mov_b32 v187, 0
    v_mov_b32 v188, 0
    v_mov_b32 v189, 0
    v_mov_b32 v190, 0
    v_mov_b32 v191, 0
    v_mov_b32 v192, 0
    v_mov_b32 v193, 0
    v_mov_b32 v194, 0
    v_mov_b32 v195, 0
    v_mov_b32 v196, 0
    v_mov_b32 v197, 0
    v_mov_b32 v198, 0
    v_mov_b32 v199, 0
    v_mov_b32 v200, 0
    v_mov_b32 v201, 0
    v_mov_b32 v202, 0
    v_mov_b32 v203, 0
    v_mov_b32 v204, 0
    v_mov_b32 v205, 0
    v_mov_b32 v206, 0
    v_mov_b32 v207, 0
    v_mfma_f32_32x32x16_f16 v[176:191], v[208:211], v[64:67], v[176:191]
    v_mfma_f32_32x32x16_f16 v[176:191], v[212:215], v[68:71], v[176:191]
    v_mfma_f32_32x32x16_f16 v[176:191], v[216:219], v[72:75], v[176:191]
    v_mfma_f32_32x32x16_f16 v[176:191], v[220:223], v[76:79], v[176:191]
    v_mfma_f32_32x32x16_f16 v[192:207], v[208:211], v[96:99], v[192:207]
    v_mfma_f32_32x32x16_f16 v[192:207], v[212:215], v[100:103], v[192:207]
    v_mfma_f32_32x32x16_f16 v[192:207], v[216:219], v[104:107], v[192:207]
    v_mfma_f32_32x32x16_f16 v[192:207], v[220:223], v[108:111], v[192:207]
    ds_read_b128 v[240:243], v2 offset:36864
    ds_read_b128 v[244:247], v2 offset:37888
    ds_read_b128 v[248:251], v2 offset:38912
    ds_read_b128 v[252:255], v2 offset:39936
    s_nop 7
    v_sub_f32 v176, v176, v193
    v_add_f32 v177, v177, v192
    v_sub_f32 v178, v178, v195
    v_add_f32 v179, v179, v194
    v_sub_f32 v180, v180, v197
    v_add_f32 v181, v181, v196
    v_sub_f32 v182, v182, v199
    v_add_f32 v183, v183, v198
    v_sub_f32 v184, v184, v201
    v_add_f32 v185, v185, v200
    v_sub_f32 v186, v186, v203
    v_add_f32 v187, v187, v202
    v_sub_f32 v188, v188, v205
    v_add_f32 v189, v189, v204
    v_sub_f32 v190, v190, v207
    v_add_f32 v191, v191, v206
    s_waitcnt lgkmcnt(0)
    v_mul_f32 v192, v176, v240
    v_fma_f32 v192, -v177, v241, v192
    v_mul_f32 v193, v176, v241
    v_fmac_f32 v193, v177, v240
    v_cvt_pk_f16_f32 v128, v192, -v193
    v_mul_f32 v194, v178, v242
    v_fma_f32 v194, -v179, v243, v194
    v_mul_f32 v195, v178, v243
    v_fmac_f32 v195, v179, v242
    v_cvt_pk_f16_f32 v129, v194, -v195
    v_mul_f32 v196, v180, v244
    v_fma_f32 v196, -v181, v245, v196
    v_mul_f32 v197, v180, v245
    v_fmac_f32 v197, v181, v244
    v_cvt_pk_f16_f32 v130, v196, -v197
    v_mul_f32 v198, v182, v246
    v_fma_f32 v198, -v183, v247, v198
    v_mul_f32 v199, v182, v247
    v_fmac_f32 v199, v183, v246
    v_cvt_pk_f16_f32 v131, v198, -v199
    v_mul_f32 v200, v184, v248
    v_fma_f32 v200, -v185, v249, v200
    v_mul_f32 v201, v184, v249
    v_fmac_f32 v201, v185, v248
    v_cvt_pk_f16_f32 v132, v200, -v201
    v_mul_f32 v202, v186, v250
    v_fma_f32 v202, -v187, v251, v202
    v_mul_f32 v203, v186, v251
    v_fmac_f32 v203, v187, v250
    v_cvt_pk_f16_f32 v133, v202, -v203
    v_mul_f32 v204, v188, v252
    v_fma_f32 v204, -v189, v253, v204
    v_mul_f32 v205, v188, v253
    v_fmac_f32 v205, v189, v252
    v_cvt_pk_f16_f32 v134, v204, -v205
    v_mul_f32 v206, v190, v254
    v_fma_f32 v206, -v191, v255, v206
    v_mul_f32 v207, v190, v255
    v_fmac_f32 v207, v191, v254
    v_cvt_pk_f16_f32 v135, v206, -v207
    v_mov_b32 v144, 0
    v_mov_b32 v145, 0
    v_mov_b32 v146, 0
    v_mov_b32 v147, 0
    v_mov_b32 v148, 0
    v_mov_b32 v149, 0
    v_mov_b32 v150, 0
    v_mov_b32 v151, 0
    v_mov_b32 v152, 0
    v_mov_b32 v153, 0
    v_mov_b32 v154, 0
    v_mov_b32 v155, 0
    v_mov_b32 v156, 0
    v_mov_b32 v157, 0
    v_mov_b32 v158, 0
    v_mov_b32 v159, 0
    v_mov_b32 v160, 0
    v_mov_b32 v161, 0
    v_mov_b32 v162, 0
    v_mov_b32 v163, 0
    v_mov_b32 v164, 0
    v_mov_b32 v165, 0
    v_mov_b32 v166, 0
    v_mov_b32 v167, 0
    v_mov_b32 v168, 0
    v_mov_b32 v169, 0
    v_mov_b32 v170, 0
    v_mov_b32 v171, 0
    v_mov_b32 v172, 0
    v_mov_b32 v173, 0
    v_mov_b32 v174, 0
    v_mov_b32 v175, 0
    v_mfma_f32_32x32x16_f16 v[144:159], v[224:227], v[48:51], v[144:159]
    v_mfma_f32_32x32x16_f16 v[144:159], v[228:231], v[52:55], v[144:159]
    v_mfma_f32_32x32x16_f16 v[144:159], v[232:235], v[56:59], v[144:159]
    v_mfma_f32_32x32x16_f16 v[144:159], v[236:239], v[60:63], v[144:159]
    v_mfma_f32_32x32x16_f16 v[160:175], v[224:227], v[80:83], v[160:175]
    v_mfma_f32_32x32x16_f16 v[160:175], v[228:231], v[84:87], v[160:175]
    v_mfma_f32_32x32x16_f16 v[160:175], v[232:235], v[88:91], v[160:175]
    v_mfma_f32_32x32x16_f16 v[160:175], v[236:239], v[92:95], v[160:175]
    ds_read_b128 v[240:243], v2 offset:40960
    ds_read_b128 v[244:247], v2 offset:41984
    ds_read_b128 v[248:251], v2 offset:43008
    ds_read_b128 v[252:255], v2 offset:44032
    s_nop 7
    v_sub_f32 v144, v144, v161
    v_add_f32 v145, v145, v160
    v_sub_f32 v146, v146, v163
    v_add_f32 v147, v147, v162
    v_sub_f32 v148, v148, v165
    v_add_f32 v149, v149, v164
    v_sub_f32 v150, v150, v167
    v_add_f32 v151, v151, v166
    v_sub_f32 v152, v152, v169
    v_add_f32 v153, v153, v168
    v_sub_f32 v154, v154, v171
    v_add_f32 v155, v155, v170
    v_sub_f32 v156, v156, v173
    v_add_f32 v157, v157, v172
    v_sub_f32 v158, v158, v175
    v_add_f32 v159, v159, v174
    s_waitcnt lgkmcnt(0)
    v_mul_f32 v160, v144, v240
    v_fma_f32 v160, -v145, v241, v160
    v_mul_f32 v161, v144, v241
    v_fmac_f32 v161, v145, v240
    v_cvt_pk_f16_f32 v120, v160, -v161
    v_mul_f32 v162, v146, v242
    v_fma_f32 v162, -v147, v243, v162
    v_mul_f32 v163, v146, v243
    v_fmac_f32 v163, v147, v242
    v_cvt_pk_f16_f32 v121, v162, -v163
    v_mul_f32 v164, v148, v244
    v_fma_f32 v164, -v149, v245, v164
    v_mul_f32 v165, v148, v245
    v_fmac_f32 v165, v149, v244
    v_cvt_pk_f16_f32 v122, v164, -v165
    v_mul_f32 v166, v150, v246
    v_fma_f32 v166, -v151, v247, v166
    v_mul_f32 v167, v150, v247
    v_fmac_f32 v167, v151, v246
    v_cvt_pk_f16_f32 v123, v166, -v167
    v_mul_f32 v168, v152, v248
    v_fma_f32 v168, -v153, v249, v168
    v_mul_f32 v169, v152, v249
    v_fmac_f32 v169, v153, v248
    v_cvt_pk_f16_f32 v124, v168, -v169
    v_mul_f32 v170, v154, v250
    v_fma_f32 v170, -v155, v251, v170
    v_mul_f32 v171, v154, v251
    v_fmac_f32 v171, v155, v250
    v_cvt_pk_f16_f32 v125, v170, -v171
    v_mul_f32 v172, v156, v252
    v_fma_f32 v172, -v157, v253, v172
    v_mul_f32 v173, v156, v253
    v_fmac_f32 v173, v157, v252
    v_cvt_pk_f16_f32 v126, v172, -v173
    v_mul_f32 v174, v158, v254
    v_fma_f32 v174, -v159, v255, v174
    v_mul_f32 v175, v158, v255
    v_fmac_f32 v175, v159, v254
    v_cvt_pk_f16_f32 v127, v174, -v175
    v_mov_b32 v176, 0
    v_mov_b32 v177, 0
    v_mov_b32 v178, 0
    v_mov_b32 v179, 0
    v_mov_b32 v180, 0
    v_mov_b32 v181, 0
    v_mov_b32 v182, 0
    v_mov_b32 v183, 0
    v_mov_b32 v184, 0
    v_mov_b32 v185, 0
    v_mov_b32 v186, 0
    v_mov_b32 v187, 0
    v_mov_b32 v188, 0
    v_mov_b32 v189, 0
    v_mov_b32 v190, 0
    v_mov_b32 v191, 0
    v_mov_b32 v192, 0
    v_mov_b32 v193, 0
    v_mov_b32 v194, 0
    v_mov_b32 v195, 0
    v_mov_b32 v196, 0
    v_mov_b32 v197, 0
    v_mov_b32 v198, 0
    v_mov_b32 v199, 0
    v_mov_b32 v200, 0
    v_mov_b32 v201, 0
    v_mov_b32 v202, 0
    v_mov_b32 v203, 0
    v_mov_b32 v204, 0
    v_mov_b32 v205, 0
    v_mov_b32 v206, 0
    v_mov_b32 v207, 0
    v_mfma_f32_32x32x16_f16 v[176:191], v[224:227], v[64:67], v[176:191]
    v_mfma_f32_32x32x16_f16 v[176:191], v[228:231], v[68:71], v[176:191]
    v_mfma_f32_32x32x16_f16 v[176:191], v[232:235], v[72:75], v[176:191]
    v_mfma_f32_32x32x16_f16 v[176:191], v[236:239], v[76:79], v[176:191]
    v_mfma_f32_32x32x16_f16 v[192:207], v[224:227], v[96:99], v[192:207]
    v_mfma_f32_32x32x16_f16 v[192:207], v[228:231], v[100:103], v[192:207]
    v_mfma_f32_32x32x16_f16 v[192:207], v[232:235], v[104:107], v[192:207]
    v_mfma_f32_32x32x16_f16 v[192:207], v[236:239], v[108:111], v[192:207]
    ds_read_b128 v[240:243], v2 offset:45056
    ds_read_b128 v[244:247], v2 offset:46080
    ds_read_b128 v[248:251], v2 offset:47104
    ds_read_b128 v[252:255], v2 offset:48128
    s_nop 7
    v_sub_f32 v176, v176, v193
    v_add_f32 v177, v177, v192
    v_sub_f32 v178, v178, v195
    v_add_f32 v179, v179, v194
    v_sub_f32 v180, v180, v197
    v_add_f32 v181, v181, v196
    v_sub_f32 v182, v182, v199
    v_add_f32 v183, v183, v198
    v_sub_f32 v184, v184, v201
    v_add_f32 v185, v185, v200
    v_sub_f32 v186, v186, v203
    v_add_f32 v187, v187, v202
    v_sub_f32 v188, v188, v205
    v_add_f32 v189, v189, v204
    v_sub_f32 v190, v190, v207
    v_add_f32 v191, v191, v206
    s_waitcnt lgkmcnt(0)
    v_mul_f32 v192, v176, v240
    v_fma_f32 v192, -v177, v241, v192
    v_mul_f32 v193, v176, v241
    v_fmac_f32 v193, v177, v240
    v_cvt_pk_f16_f32 v136, v192, -v193
    v_mul_f32 v194, v178, v242
    v_fma_f32 v194, -v179, v243, v194
    v_mul_f32 v195, v178, v243
    v_fmac_f32 v195, v179, v242
    v_cvt_pk_f16_f32 v137, v194, -v195
    v_mul_f32 v196, v180, v244
    v_fma_f32 v196, -v181, v245, v196
    v_mul_f32 v197, v180, v245
    v_fmac_f32 v197, v181, v244
    v_cvt_pk_f16_f32 v138, v196, -v197
    v_mul_f32 v198, v182, v246
    v_fma_f32 v198, -v183, v247, v198
    v_mul_f32 v199, v182, v247
    v_fmac_f32 v199, v183, v246
    v_cvt_pk_f16_f32 v139, v198, -v199
    v_mul_f32 v200, v184, v248
    v_fma_f32 v200, -v185, v249, v200
    v_mul_f32 v201, v184, v249
    v_fmac_f32 v201, v185, v248
    v_cvt_pk_f16_f32 v140, v200, -v201
    v_mul_f32 v202, v186, v250
    v_fma_f32 v202, -v187, v251, v202
    v_mul_f32 v203, v186, v251
    v_fmac_f32 v203, v187, v250
    v_cvt_pk_f16_f32 v141, v202, -v203
    v_mul_f32 v204, v188, v252
    v_fma_f32 v204, -v189, v253, v204
    v_mul_f32 v205, v188, v253
    v_fmac_f32 v205, v189, v252
    v_cvt_pk_f16_f32 v142, v204, -v205
    v_mul_f32 v206, v190, v254
    v_fma_f32 v206, -v191, v255, v206
    v_mul_f32 v207, v190, v255
    v_fmac_f32 v207, v191, v254
    v_cvt_pk_f16_f32 v143, v206, -v207
    v_mov_b32 v144, 0
    v_mov_b32 v145, 0
    v_mov_b32 v146, 0
    v_mov_b32 v147, 0
    v_mov_b32 v148, 0
    v_mov_b32 v149, 0
    v_mov_b32 v150, 0
    v_mov_b32 v151, 0
    v_mov_b32 v152, 0
    v_mov_b32 v153, 0
    v_mov_b32 v154, 0
    v_mov_b32 v155, 0
    v_mov_b32 v156, 0
    v_mov_b32 v157, 0
    v_mov_b32 v158, 0
    v_mov_b32 v159, 0
    v_mov_b32 v160, 0
    v_mov_b32 v161, 0
    v_mov_b32 v162, 0
    v_mov_b32 v163, 0
    v_mov_b32 v164, 0
    v_mov_b32 v165, 0
    v_mov_b32 v166, 0
    v_mov_b32 v167, 0
    v_mov_b32 v168, 0
    v_mov_b32 v169, 0
    v_mov_b32 v170, 0
    v_mov_b32 v171, 0
    v_mov_b32 v172, 0
    v_mov_b32 v173, 0
    v_mov_b32 v174, 0
    v_mov_b32 v175, 0
    v_mov_b32 v176, 0
    v_mov_b32 v177, 0
    v_mov_b32 v178, 0
    v_mov_b32 v179, 0
    v_mov_b32 v180, 0
    v_mov_b32 v181, 0
    v_mov_b32 v182, 0
    v_mov_b32 v183, 0
    v_mov_b32 v184, 0
    v_mov_b32 v185, 0
    v_mov_b32 v186, 0
    v_mov_b32 v187, 0
    v_mov_b32 v188, 0
    v_mov_b32 v189, 0
    v_mov_b32 v190, 0
    v_mov_b32 v191, 0
    v_mov_b32 v192, 0
    v_mov_b32 v193, 0
    v_mov_b32 v194, 0
    v_mov_b32 v195, 0
    v_mov_b32 v196, 0
    v_mov_b32 v197, 0
    v_mov_b32 v198, 0
    v_mov_b32 v199, 0
    v_mov_b32 v200, 0
    v_mov_b32 v201, 0
    v_mov_b32 v202, 0
    v_mov_b32 v203, 0
    v_mov_b32 v204, 0
    v_mov_b32 v205, 0
    v_mov_b32 v206, 0
    v_mov_b32 v207, 0
    v_mfma_f32_32x32x16_f16 v[144:159], v[112:115], v[16:19], v[144:159]
    v_mfma_f32_32x32x16_f16 v[144:159], v[116:119], v[20:23], v[144:159]
    v_mfma_f32_32x32x16_f16 v[144:159], v[120:123], v[24:27], v[144:159]
    v_mfma_f32_32x32x16_f16 v[144:159], v[124:127], v[28:31], v[144:159]
    v_mfma_f32_32x32x16_f16 v[160:175], v[112:115], v[32:35], v[160:175]
    v_mfma_f32_32x32x16_f16 v[160:175], v[116:119], v[36:39], v[160:175]
    v_mfma_f32_32x32x16_f16 v[160:175], v[120:123], v[40:43], v[160:175]
    v_mfma_f32_32x32x16_f16 v[160:175], v[124:127], v[44:47], v[160:175]
    v_mfma_f32_32x32x16_f16 v[176:191], v[128:131], v[16:19], v[176:191]
    v_mfma_f32_32x32x16_f16 v[176:191], v[132:135], v[20:23], v[176:191]
    v_mfma_f32_32x32x16_f16 v[176:191], v[136:139], v[24:27], v[176:191]
    v_mfma_f32_32x32x16_f16 v[176:191], v[140:143], v[28:31], v[176:191]
    v_mfma_f32_32x32x16_f16 v[192:207], v[128:131], v[32:35], v[192:207]
    v_mfma_f32_32x32x16_f16 v[192:207], v[132:135], v[36:39], v[192:207]
    v_mfma_f32_32x32x16_f16 v[192:207], v[136:139], v[40:43], v[192:207]
    v_mfma_f32_32x32x16_f16 v[192:207], v[140:143], v[44:47], v[192:207]
    v_bfe_u32 v9, v1, 1, 4
    v_lshlrev_b32 v9, 7, v9
    v_lshrrev_b32 v10, 5, v1
    v_lshl_add_u32 v9, v10, 4, v9
    v_and_b32 v10, 1, v1
    v_lshl_add_u32 v9, v10, 12, v9
    s_lshl_b32 s36, s28, 13
    s_cmp_eq_u32 s28, 288
    s_cselect_b32 s36, 4096, s36
    s_add_u32 s36, s36, 13238272
    s_cmp_eq_u32 s28, 0
    s_cbranch_scc1 F_MASK
    s_cmp_lg_u32 s28, 288
    s_cbranch_scc1 F_NOMASK
F_MASK:
    s_mov_b32 exec_lo, 0x55555555
    s_mov_b32 exec_hi, 0x55555555
F_NOMASK:
    v_cvt_pk_f16_f32 v112, v144, v145
    v_cvt_pk_f16_f32 v113, v146, v147
    v_cvt_pk_f16_f32 v114, v148, v149
    v_cvt_pk_f16_f32 v115, v150, v151
    v_cvt_pk_f16_f32 v116, v152, v153
    v_cvt_pk_f16_f32 v117, v154, v155
    v_cvt_pk_f16_f32 v118, v156, v157
    v_cvt_pk_f16_f32 v119, v158, v159
    v_cvt_pk_f16_f32 v120, v160, v161
    v_cvt_pk_f16_f32 v121, v162, v163
    v_cvt_pk_f16_f32 v122, v164, v165
    v_cvt_pk_f16_f32 v123, v166, v167
    v_cvt_pk_f16_f32 v124, v168, v169
    v_cvt_pk_f16_f32 v125, v170, v171
    v_cvt_pk_f16_f32 v126, v172, v173
    v_cvt_pk_f16_f32 v127, v174, v175
    v_cvt_pk_f16_f32 v128, v176, v177
    v_cvt_pk_f16_f32 v129, v178, v179
    v_cvt_pk_f16_f32 v130, v180, v181
    v_cvt_pk_f16_f32 v131, v182, v183
    v_cvt_pk_f16_f32 v132, v184, v185
    v_cvt_pk_f16_f32 v133, v186, v187
    v_cvt_pk_f16_f32 v134, v188, v189
    v_cvt_pk_f16_f32 v135, v190, v191
    v_cvt_pk_f16_f32 v136, v192, v193
    v_cvt_pk_f16_f32 v137, v194, v195
    v_cvt_pk_f16_f32 v138, v196, v197
    v_cvt_pk_f16_f32 v139, v198, v199
    v_cvt_pk_f16_f32 v140, v200, v201
    v_cvt_pk_f16_f32 v141, v202, v203
    v_cvt_pk_f16_f32 v142, v204, v205
    v_cvt_pk_f16_f32 v143, v206, v207
    s_mov_b64 s[40:41], exec
    s_mov_b64 exec, -1
    v_permlane32_swap_b32 v112, v114
    v_permlane32_swap_b32 v113, v115
    v_permlane32_swap_b32 v116, v118
    v_permlane32_swap_b32 v117, v119
    v_permlane32_swap_b32 v120, v122
    v_permlane32_swap_b32 v121, v123
    v_permlane32_swap_b32 v124, v126
    v_permlane32_swap_b32 v125, v127
    v_permlane32_swap_b32 v128, v130
    v_permlane32_swap_b32 v129, v131
    v_permlane32_swap_b32 v132, v134
    v_permlane32_swap_b32 v133, v135
    v_permlane32_swap_b32 v136, v138
    v_permlane32_swap_b32 v137, v139
    v_permlane32_swap_b32 v140, v142
    v_permlane32_swap_b32 v141, v143
    s_mov_b64 exec, s[40:41]
    buffer_store_dwordx4 v[112:115], v9, s[24:27], s36 offen offset:0
    buffer_store_dwordx4 v[116:119], v9, s[24:27], s36 offen offset:32
    buffer_store_dwordx4 v[120:123], v9, s[24:27], s36 offen offset:2048
    buffer_store_dwordx4 v[124:127], v9, s[24:27], s36 offen offset:2080
    buffer_store_dwordx4 v[128:131], v9, s[24:27], s36 offen offset:64
    buffer_store_dwordx4 v[132:135], v9, s[24:27], s36 offen offset:96
    buffer_store_dwordx4 v[136:139], v9, s[24:27], s36 offen offset:2112
    buffer_store_dwordx4 v[140:143], v9, s[24:27], s36 offen offset:2144
K2_END:
    s_endpgm

.globl k3_kernel
.p2align 8
.type k3_kernel,@function
k3_kernel:
    s_cmp_ge_u32 s2, 256
    s_cbranch_scc1 K3_END
    s_load_dwordx2 s[4:5], s[0:1], 0
    s_load_dwordx4 s[8:11], s[0:1], 48
    s_load_dwordx2 s[6:7], s[0:1], 64
    s_load_dwordx2 s[28:29], s[0:1], 80
    v_and_b32 v1, 63, v0
    v_lshrrev_b32 v2, 6, v0
    s_nop 0
    v_readfirstlane_b32 s3, v2
    s_and_b32 s36, s2, 7
    s_lshr_b32 s37, s2, 3
    s_lshl_b32 s36, s36, 2
    s_and_b32 s38, s37, 3
    s_add_u32 s36, s36, s38
    s_lshr_b32 s37, s37, 2
    s_lshl_b32 s38, s36, 7
    s_mul_i32 s39, s37, 72
    s_waitcnt lgkmcnt(0)
    s_add_u32 s16, s28, 13238272
    s_addc_u32 s17, s29, 0
    s_mov_b32 s18, 2359296
    s_mov_b32 s19, 0x00020000
    s_mov_b32 s12, s28
    s_mov_b32 s13, s29
    s_mov_b32 s14, 15728640
    s_mov_b32 s15, 0x00020000
    s_mov_b32 s20, s4
    s_mov_b32 s21, s5
    s_mov_b32 s22, 2359296
    s_mov_b32 s23, 0x00020000
    s_mov_b32 s24, s6
    s_mov_b32 s25, s7
    s_mov_b32 s26, 2359296
    s_mov_b32 s27, 0x00020000
    s_mov_b32 s32, s10
    s_mov_b32 s33, s11
    s_mov_b32 s34, 4096
    s_mov_b32 s35, 0x00020000
    s_cmp_lt_u32 s3, 4
    s_cbranch_scc1 K3_CONS
    s_sub_u32 s3, s3, 4
    v_lshrrev_b32 v7, 3, v1
    v_and_b32 v8, 7, v1
    v_lshrrev_b32 v9, 4, v1
    v_xor_b32 v10, v8, v9
    v_mul_u32_u24 v11, 10368, v7
    v_lshl_add_u32 v2, v10, 4, v11
    v_xor_b32 v10, 4, v10
    v_lshl_add_u32 v3, v10, 4, v11
    v_add_u32 v3, 81920, v3
    v_xor_b32 v10, s3, v8
    v_lshl_add_u32 v4, v10, 4, v11
    v_bfe_u32 v10, v1, 4, 1
    v_lshlrev_b32 v10, 1, v10
    v_xor_b32 v10, v10, v8
    v_lshlrev_b32 v11, 12, v7
    v_lshl_add_u32 v5, v10, 4, v11
    v_xor_b32 v10, 4, v10
    v_lshl_add_u32 v6, v10, 4, v11
    v_add_u32 v6, 31744, v6
    s_mul_i32 s40, s39, 10368
    s_add_u32 s40, s40, 7208960
    s_mul_i32 s41, s3, 165888
    s_add_u32 s41, s41, s40
    s_mul_i32 s42, s3, 20736
    s_add_u32 s42, s42, s40
    s_add_u32 s42, s42, 663552
    s_lshl_b32 s43, s3, 16
    s_add_u32 s43, s43, s38
    s_mov_b32 s44, s43
    s_lshl_b32 s45, s3, 11
    s_lshl_b32 s46, s3, 8
    s_add_u32 s46, s46, 8192
    s_add_u32 s47, s45, 9216
    s_mov_b32 s48, 0
    s_mov_b32 s49, 0
    s_cmp_eq_u32 s49, 9
    s_cselect_b32 s16, s8, s16
    s_cselect_b32 s17, s9, s17
    s_cselect_b32 s18, 18874368, s18
    s_cselect_b32 s43, s44, s43
    s_add_u32 s50, s48, s45
    s_mov_b32 m0, s50
    s_add_u32 s50, s48, s47
    buffer_load_dwordx4 v2, s[12:15], s41 offen lds
    buffer_load_dwordx4 v3, s[12:15], s41 offen offset:1024 lds
    s_mov_b32 m0, s50
    s_add_u32 s50, s48, s46
    buffer_load_dwordx4 v5, s[16:19], s43 offen lds
    buffer_load_dwordx4 v6, s[16:19], s43 offen offset:1024 lds
    s_mov_b32 m0, s50
    s_mov_b64 exec, 0xffff
    buffer_load_dwordx4 v4, s[12:15], s42 offen lds
    s_mov_b64 exec, -1
    s_add_u32 s41, s41, 128
    s_add_u32 s42, s42, 128
    s_add_u32 s43, s43, 262144
    s_add_u32 s49, s49, 1
    s_add_u32 s48, s48, 17408
    s_cmp_ge_u32 s48, 156672
    s_cselect_b32 s48, 0, s48
    s_cmp_eq_u32 s49, 9
    s_cselect_b32 s16, s8, s16
    s_cselect_b32 s17, s9, s17
    s_cselect_b32 s18, 18874368, s18
    s_cselect_b32 s43, s44, s43
    s_add_u32 s50, s48, s45
    s_mov_b32 m0, s50
    s_add_u32 s50, s48, s47
    buffer_load_dwordx4 v2, s[12:15], s41 offen lds
    buffer_load_dwordx4 v3, s[12:15], s41 offen offset:1024 lds
    s_mov_b32 m0, s50
    s_add_u32 s50, s48, s46
    buffer_load_dwordx4 v5, s[16:19], s43 offen lds
    buffer_load_dwordx4 v6, s[16:19], s43 offen offset:1024 lds
    s_mov_b32 m0, s50
    s_mov_b64 exec, 0xffff
    buffer_load_dwordx4 v4, s[12:15], s42 offen lds
    s_mov_b64 exec, -1
    s_add_u32 s41, s41, 128
    s_add_u32 s42, s42, 128
    s_add_u32 s43, s43, 262144
    s_add_u32 s49, s49, 1
    s_add_u32 s48, s48, 17408
    s_cmp_ge_u32 s48, 156672
    s_cselect_b32 s48, 0, s48
    s_cmp_eq_u32 s49, 9
    s_cselect_b32 s16, s8, s16
    s_cselect_b32 s17, s9, s17
    s_cselect_b32 s18, 18874368, s18
    s_cselect_b32 s43, s44, s43
    s_add_u32 s50, s48, s45
    s_mov_b32 m0, s50
    s_add_u32 s50, s48, s47
    buffer_load_dwordx4 v2, s[12:15], s41 offen lds
    buffer_load_dwordx4 v3, s[12:15], s41 offen offset:1024 lds
    s_mov_b32 m0, s50
    s_add_u32 s50, s48, s46
    buffer_load_dwordx4 v5, s[16:19], s43 offen lds
    buffer_load_dwordx4 v6, s[16:19], s43 offen offset:1024 lds
    s_mov_b32 m0, s50
    s_mov_b64 exec, 0xffff
    buffer_load_dwordx4 v4, s[12:15], s42 offen lds
    s_mov_b64 exec, -1
    s_add_u32 s41, s41, 128
    s_add_u32 s42, s42, 128
    s_add_u32 s43, s43, 262144
    s_add_u32 s49, s49, 1
    s_add_u32 s48, s48, 17408
    s_cmp_ge_u32 s48, 156672
    s_cselect_b32 s48, 0, s48
    s_cmp_eq_u32 s49, 9
    s_cselect_b32 s16, s8, s16
    s_cselect_b32 s17, s9, s17
    s_cselect_b32 s18, 18874368, s18
    s_cselect_b32 s43, s44, s43
    s_add_u32 s50, s48, s45
    s_mov_b32 m0, s50
    s_add_u32 s50, s48, s47
    buffer_load_dwordx4 v2, s[12:15], s41 offen lds
    buffer_load_dwordx4 v3, s[12:15], s41 offen offset:1024 lds
    s_mov_b32 m0, s50
    s_add_u32 s50, s48, s46
    buffer_load_dwordx4 v5, s[16:19], s43 offen lds
    buffer_load_dwordx4 v6, s[16:19], s43 offen offset:1024 lds
    s_mov_b32 m0, s50
    s_mov_b64 exec, 0xffff
    buffer_load_dwordx4 v4, s[12:15], s42 offen lds
    s_mov_b64 exec, -1
    s_add_u32 s41, s41, 128
    s_add_u32 s42, s42, 128
    s_add_u32 s43, s43, 262144
    s_add_u32 s49, s49, 1
    s_add_u32 s48, s48, 17408
    s_cmp_ge_u32 s48, 156672
    s_cselect_b32 s48, 0, s48
    s_cmp_eq_u32 s49, 9
    s_cselect_b32 s16, s8, s16
    s_cselect_b32 s17, s9, s17
    s_cselect_b32 s18, 18874368, s18
    s_cselect_b32 s43, s44, s43
    s_add_u32 s50, s48, s45
    s_mov_b32 m0, s50
    s_add_u32 s50, s48, s47
    buffer_load_dwordx4 v2, s[12:15], s41 offen lds
    buffer_load_dwordx4 v3, s[12:15], s41 offen offset:1024 lds
    s_mov_b32 m0, s50
    s_add_u32 s50, s48, s46
    buffer_load_dwordx4 v5, s[16:19], s43 offen lds
    buffer_load_dwordx4 v6, s[16:19], s43 offen offset:1024 lds
    s_mov_b32 m0, s50
    s_mov_b64 exec, 0xffff
    buffer_load_dwordx4 v4, s[12:15], s42 offen lds
    s_mov_b64 exec, -1
    s_add_u32 s41, s41, 128
    s_add_u32 s42, s42, 128
    s_add_u32 s43, s43, 262144
    s_add_u32 s49, s49, 1
    s_add_u32 s48, s48, 17408
    s_cmp_ge_u32 s48, 156672
    s_cselect_b32 s48, 0, s48
    s_cmp_eq_u32 s49, 9
    s_cselect_b32 s16, s8, s16
    s_cselect_b32 s17, s9, s17
    s_cselect_b32 s18, 18874368, s18
    s_cselect_b32 s43, s44, s43
    s_add_u32 s50, s48, s45
    s_mov_b32 m0, s50
    s_add_u32 s50, s48, s47
    buffer_load_dwordx4 v2, s[12:15], s41 offen lds
    buffer_load_dwordx4 v3, s[12:15], s41 offen offset:1024 lds
    s_mov_b32 m0, s50
    s_add_u32 s50, s48, s46
    buffer_load_dwordx4 v5, s[16:19], s43 offen lds
    buffer_load_dwordx4 v6, s[16:19], s43 offen offset:1024 lds
    s_mov_b32 m0, s50
    s_mov_b64 exec, 0xffff
    buffer_load_dwordx4 v4, s[12:15], s42 offen lds
    s_mov_b64 exec, -1
    s_add_u32 s41, s41, 128
    s_add_u32 s42, s42, 128
    s_add_u32 s43, s43, 262144
    s_add_u32 s49, s49, 1
    s_add_u32 s48, s48, 17408
    s_cmp_ge_u32 s48, 156672
    s_cselect_b32 s48, 0, s48
    s_cmp_eq_u32 s49, 9
    s_cselect_b32 s16, s8, s16
    s_cselect_b32 s17, s9, s17
    s_cselect_b32 s18, 18874368, s18
    s_cselect_b32 s43, s44, s43
    s_add_u32 s50, s48, s45
    s_mov_b32 m0, s50
    s_add_u32 s50, s48, s47
    buffer_load_dwordx4 v2, s[12:15], s41 offen lds
    buffer_load_dwordx4 v3, s[12:15], s41 offen offset:1024 lds
    s_mov_b32 m0, s50
    s_add_u32 s50, s48, s46
    buffer_load_dwordx4 v5, s[16:19], s43 offen lds
    buffer_load_dwordx4 v6, s[16:19], s43 offen offset:1024 lds
    s_mov_b32 m0, s50
    s_mov_b64 exec, 0xffff
    buffer_load_dwordx4 v4, s[12:15], s42 offen lds
    s_mov_b64 exec, -1
    s_add_u32 s41, s41, 128
    s_add_u32 s42, s42, 128
    s_add_u32 s43, s43, 262144
    s_add_u32 s49, s49, 1
    s_add_u32 s48, s48, 17408
    s_cmp_ge_u32 s48, 156672
    s_cselect_b32 s48, 0, s48
    s_cmp_eq_u32 s49, 9
    s_cselect_b32 s16, s8, s16
    s_cselect_b32 s17, s9, s17
    s_cselect_b32 s18, 18874368, s18
    s_cselect_b32 s43, s44, s43
    s_add_u32 s50, s48, s45
    s_mov_b32 m0, s50
    s_add_u32 s50, s48, s47
    buffer_load_dwordx4 v2, s[12:15], s41 offen lds
    buffer_load_dwordx4 v3, s[12:15], s41 offen offset:1024 lds
    s_mov_b32 m0, s50
    s_add_u32 s50, s48, s46
    buffer_load_dwordx4 v5, s[16:19], s43 offen lds
    buffer_load_dwordx4 v6, s[16:19], s43 offen offset:1024 lds
    s_mov_b32 m0, s50
    s_mov_b64 exec, 0xffff
    buffer_load_dwordx4 v4, s[12:15], s42 offen lds
    s_mov_b64 exec, -1
    s_add_u32 s41, s41, 128
    s_add_u32 s42, s42, 128
    s_add_u32 s43, s43, 262144
    s_add_u32 s49, s49, 1
    s_add_u32 s48, s48, 17408
    s_cmp_ge_u32 s48, 156672
    s_cselect_b32 s48, 0, s48
    s_waitcnt vmcnt(30)
    s_barrier
    s_mov_b32 s53, 0
K3_LLOOP:
    s_waitcnt vmcnt(25)
    s_barrier
    s_cmp_eq_u32 s49, 9
    s_cselect_b32 s16, s8, s16
    s_cselect_b32 s17, s9, s17
    s_cselect_b32 s18, 18874368, s18
    s_cselect_b32 s43, s44, s43
    s_add_u32 s50, s48, s45
    s_mov_b32 m0, s50
    s_add_u32 s50, s48, s47
    buffer_load_dwordx4 v2, s[12:15], s41 offen lds
    buffer_load_dwordx4 v3, s[12:15], s41 offen offset:1024 lds
    s_mov_b32 m0, s50
    s_add_u32 s50, s48, s46
    buffer_load_dwordx4 v5, s[16:19], s43 offen lds
    buffer_load_dwordx4 v6, s[16:19], s43 offen offset:1024 lds
    s_mov_b32 m0, s50
    s_mov_b64 exec, 0xffff
    buffer_load_dwordx4 v4, s[12:15], s42 offen lds
    s_mov_b64 exec, -1
    s_add_u32 s41, s41, 128
    s_add_u32 s42, s42, 128
    s_add_u32 s43, s43, 262144
    s_add_u32 s49, s49, 1
    s_add_u32 s48, s48, 17408
    s_cmp_ge_u32 s48, 156672
    s_cselect_b32 s48, 0, s48
    s_add_u32 s53, s53, 1
    s_cmp_lt_u32 s53, 73
    s_cbranch_scc1 K3_LLOOP
    s_waitcnt vmcnt(25)
    s_barrier
    s_waitcnt vmcnt(20)
    s_barrier
    s_waitcnt vmcnt(15)
    s_barrier
    s_waitcnt vmcnt(10)
    s_barrier
    s_waitcnt vmcnt(5)
    s_barrier
    s_waitcnt vmcnt(0)
    s_barrier
    s_waitcnt vmcnt(0)
    s_barrier
    s_waitcnt vmcnt(0)
    s_barrier
    s_waitcnt vmcnt(0)
    s_add_u32 s3, s3, 4
    s_endpgm
K3_CONS:
    s_and_b32 s40, s3, 1
    s_lshr_b32 s41, s3, 1
    v_and_b32 v13, 15, v1
    v_lshrrev_b32 v14, 4, v1
    v_bfe_u32 v16, v1, 1, 3
    v_xor_b32 v15, v14, v16
    v_lshlrev_b32 v13, 7, v13
    v_lshl_add_u32 v2, v15, 4, v13
    s_mul_i32 s42, s40, 6144
    v_add_u32 v2, s42, v2
    v_bfe_u32 v13, v1, 2, 2
    v_lshl_add_u32 v15, v14, 3, v13
    v_lshlrev_b32 v15, 7, v15
    v_bfe_u32 v16, v1, 1, 1
    s_lshl_b32 s42, s41, 2
    v_add_u32 v16, s42, v16
    v_bfe_u32 v17, v1, 3, 1
    v_lshlrev_b32 v17, 1, v17
    v_xor_b32 v16, v16, v17
    v_and_b32 v17, 1, v14
    v_lshlrev_b32 v17, 2, v17
    v_xor_b32 v16, v16, v17
    v_lshl_add_u32 v15, v16, 4, v15
    v_and_b32 v16, 1, v1
    v_lshl_add_u32 v15, v16, 3, v15
    v_add_u32 v3, 9216, v15
    v_xor_b32 v4, 32, v3
    s_cmp_eq_u32 s40, 1
    s_cbranch_scc1 K3_C1
    s_barrier
    s_mov_b32 s52, 0
    v_add_u32 v5, s52, v2
    v_add_u32 v6, s52, v3
    v_add_u32 v7, s52, v4
    v_xor_b32 v8, 64, v5
    ds_read_b128 v[64:67], v5 offset:0
    ds_read_b128 v[68:71], v5 offset:2048
    ds_read_b128 v[72:75], v5 offset:4096
    ds_read_b64_tr_b16 v[76:77], v6 offset:0
    ds_read_b64_tr_b16 v[78:79], v6 offset:512
    ds_read_b64_tr_b16 v[80:81], v7 offset:0
    ds_read_b64_tr_b16 v[82:83], v7 offset:512
    ds_read_b128 v[84:87], v8 offset:0
    ds_read_b128 v[88:91], v8 offset:2048
    ds_read_b128 v[92:95], v8 offset:4096
    ds_read_b64_tr_b16 v[96:97], v6 offset:4096
    ds_read_b64_tr_b16 v[98:99], v6 offset:4608
    ds_read_b64_tr_b16 v[100:101], v7 offset:4096
    ds_read_b64_tr_b16 v[102:103], v7 offset:4608
    s_add_u32 s52, s52, 17408
    s_cmp_ge_u32 s52, 156672
    s_cselect_b32 s52, 0, s52
    v_add_u32 v5, s52, v2
    v_add_u32 v6, s52, v3
    v_add_u32 v7, s52, v4
    v_xor_b32 v8, 64, v5
    ds_read_b128 v[104:107], v5 offset:0
    ds_read_b128 v[108:111], v5 offset:2048
    ds_read_b128 v[112:115], v5 offset:4096
    ds_read_b64_tr_b16 v[116:117], v6 offset:0
    ds_read_b64_tr_b16 v[118:119], v6 offset:512
    ds_read_b64_tr_b16 v[120:121], v7 offset:0
    ds_read_b64_tr_b16 v[122:123], v7 offset:512
    ds_read_b128 v[124:127], v8 offset:0
    ds_read_b128 v[128:131], v8 offset:2048
    ds_read_b128 v[132:135], v8 offset:4096
    ds_read_b64_tr_b16 v[136:137], v6 offset:4096
    ds_read_b64_tr_b16 v[138:139], v6 offset:4608
    ds_read_b64_tr_b16 v[140:141], v7 offset:4096
    ds_read_b64_tr_b16 v[142:143], v7 offset:4608
    s_add_u32 s52, s52, 17408
    s_cmp_ge_u32 s52, 156672
    s_cselect_b32 s52, 0, s52
    v_add_u32 v5, s52, v2
    v_add_u32 v6, s52, v3
    v_add_u32 v7, s52, v4
    v_xor_b32 v8, 64, v5
    s_waitcnt lgkmcnt(14)
    s_barrier
    v_mfma_f32_16x16x32_f16 v[16:19], v[64:67], v[76:79], 0
    ds_read_b128 v[144:147], v5 offset:0
    ds_read_b128 v[148:151], v5 offset:2048
    v_mfma_f32_16x16x32_f16 v[20:23], v[64:67], v[80:83], 0
    ds_read_b128 v[152:155], v5 offset:4096
    ds_read_b64_tr_b16 v[156:157], v6 offset:0
    v_mfma_f32_16x16x32_f16 v[24:27], v[68:71], v[76:79], 0
    ds_read_b64_tr_b16 v[158:159], v6 offset:512
    ds_read_b64_tr_b16 v[160:161], v7 offset:0
    v_mfma_f32_16x16x32_f16 v[28:31], v[68:71], v[80:83], 0
    ds_read_b64_tr_b16 v[162:163], v7 offset:512
    ds_read_b128 v[164:167], v8 offset:0
    v_mfma_f32_16x16x32_f16 v[32:35], v[72:75], v[76:79], 0
    ds_read_b128 v[168:171], v8 offset:2048
    ds_read_b128 v[172:175], v8 offset:4096
    v_mfma_f32_16x16x32_f16 v[36:39], v[72:75], v[80:83], 0
    ds_read_b64_tr_b16 v[176:177], v6 offset:4096
    ds_read_b64_tr_b16 v[178:179], v6 offset:4608
    v_mfma_f32_16x16x32_f16 v[16:19], v[84:87], v[96:99], v[16:19]
    ds_read_b64_tr_b16 v[180:181], v7 offset:4096
    ds_read_b64_tr_b16 v[182:183], v7 offset:4608
    v_mfma_f32_16x16x32_f16 v[20:23], v[84:87], v[100:103], v[20:23]
    v_mfma_f32_16x16x32_f16 v[24:27], v[88:91], v[96:99], v[24:27]
    v_mfma_f32_16x16x32_f16 v[28:31], v[88:91], v[100:103], v[28:31]
    v_mfma_f32_16x16x32_f16 v[32:35], v[92:95], v[96:99], v[32:35]
    v_mfma_f32_16x16x32_f16 v[36:39], v[92:95], v[100:103], v[36:39]
    s_add_u32 s52, s52, 17408
    s_cmp_ge_u32 s52, 156672
    s_cselect_b32 s52, 0, s52
    v_add_u32 v5, s52, v2
    v_add_u32 v6, s52, v3
    v_add_u32 v7, s52, v4
    v_xor_b32 v8, 64, v5
    s_waitcnt lgkmcnt(14)
    s_barrier
    v_mfma_f32_16x16x32_f16 v[16:19], v[104:107], v[116:119], v[16:19]
    ds_read_b128 v[64:67], v5 offset:0
    ds_read_b128 v[68:71], v5 offset:2048
    v_mfma_f32_16x16x32_f16 v[20:23], v[104:107], v[120:123], v[20:23]
    ds_read_b128 v[72:75], v5 offset:4096
    ds_read_b64_tr_b16 v[76:77], v6 offset:0
    v_mfma_f32_16x16x32_f16 v[24:27], v[108:111], v[116:119], v[24:27]
    ds_read_b64_tr_b16 v[78:79], v6 offset:512
    ds_read_b64_tr_b16 v[80:81], v7 offset:0
    v_mfma_f32_16x16x32_f16 v[28:31], v[108:111], v[120:123], v[28:31]
    ds_read_b64_tr_b16 v[82:83], v7 offset:512
    ds_read_b128 v[84:87], v8 offset:0
    v_mfma_f32_16x16x32_f16 v[32:35], v[112:115], v[116:119], v[32:35]
    ds_read_b128 v[88:91], v8 offset:2048
    ds_read_b128 v[92:95], v8 offset:4096
    v_mfma_f32_16x16x32_f16 v[36:39], v[112:115], v[120:123], v[36:39]
    ds_read_b64_tr_b16 v[96:97], v6 offset:4096
    ds_read_b64_tr_b16 v[98:99], v6 offset:4608
    v_mfma_f32_16x16x32_f16 v[16:19], v[124:127], v[136:139], v[16:19]
    ds_read_b64_tr_b16 v[100:101], v7 offset:4096
    ds_read_b64_tr_b16 v[102:103], v7 offset:4608
    v_mfma_f32_16x16x32_f16 v[20:23], v[124:127], v[140:143], v[20:23]
    v_mfma_f32_16x16x32_f16 v[24:27], v[128:131], v[136:139], v[24:27]
    v_mfma_f32_16x16x32_f16 v[28:31], v[128:131], v[140:143], v[28:31]
    v_mfma_f32_16x16x32_f16 v[32:35], v[132:135], v[136:139], v[32:35]
    v_mfma_f32_16x16x32_f16 v[36:39], v[132:135], v[140:143], v[36:39]
    s_add_u32 s52, s52, 17408
    s_cmp_ge_u32 s52, 156672
    s_cselect_b32 s52, 0, s52
    v_add_u32 v5, s52, v2
    v_add_u32 v6, s52, v3
    v_add_u32 v7, s52, v4
    v_xor_b32 v8, 64, v5
    s_waitcnt lgkmcnt(14)
    s_barrier
    v_mfma_f32_16x16x32_f16 v[16:19], v[144:147], v[156:159], v[16:19]
    ds_read_b128 v[104:107], v5 offset:0
    ds_read_b128 v[108:111], v5 offset:2048
    v_mfma_f32_16x16x32_f16 v[20:23], v[144:147], v[160:163], v[20:23]
    ds_read_b128 v[112:115], v5 offset:4096
    ds_read_b64_tr_b16 v[116:117], v6 offset:0
    v_mfma_f32_16x16x32_f16 v[24:27], v[148:151], v[156:159], v[24:27]
    ds_read_b64_tr_b16 v[118:119], v6 offset:512
    ds_read_b64_tr_b16 v[120:121], v7 offset:0
    v_mfma_f32_16x16x32_f16 v[28:31], v[148:151], v[160:163], v[28:31]
    ds_read_b64_tr_b16 v[122:123], v7 offset:512
    ds_read_b128 v[124:127], v8 offset:0
    v_mfma_f32_16x16x32_f16 v[32:35], v[152:155], v[156:159], v[32:35]
    ds_read_b128 v[128:131], v8 offset:2048
    ds_read_b128 v[132:135], v8 offset:4096
    v_mfma_f32_16x16x32_f16 v[36:39], v[152:155], v[160:163], v[36:39]
    ds_read_b64_tr_b16 v[136:137], v6 offset:4096
    ds_read_b64_tr_b16 v[138:139], v6 offset:4608
    v_mfma_f32_16x16x32_f16 v[16:19], v[164:167], v[176:179], v[16:19]
    ds_read_b64_tr_b16 v[140:141], v7 offset:4096
    ds_read_b64_tr_b16 v[142:143], v7 offset:4608
    v_mfma_f32_16x16x32_f16 v[20:23], v[164:167], v[180:183], v[20:23]
    v_mfma_f32_16x16x32_f16 v[24:27], v[168:171], v[176:179], v[24:27]
    v_mfma_f32_16x16x32_f16 v[28:31], v[168:171], v[180:183], v[28:31]
    v_mfma_f32_16x16x32_f16 v[32:35], v[172:175], v[176:179], v[32:35]
    v_mfma_f32_16x16x32_f16 v[36:39], v[172:175], v[180:183], v[36:39]
    s_mov_b32 s53, 0
K3_LA0:
    s_add_u32 s52, s52, 17408
    s_cmp_ge_u32 s52, 156672
    s_cselect_b32 s52, 0, s52
    v_add_u32 v5, s52, v2
    v_add_u32 v6, s52, v3
    v_add_u32 v7, s52, v4
    v_xor_b32 v8, 64, v5
    s_waitcnt lgkmcnt(14)
    s_barrier
    v_mfma_f32_16x16x32_f16 v[16:19], v[64:67], v[76:79], v[16:19]
    ds_read_b128 v[144:147], v5 offset:0
    ds_read_b128 v[148:151], v5 offset:2048
    v_mfma_f32_16x16x32_f16 v[20:23], v[64:67], v[80:83], v[20:23]
    ds_read_b128 v[152:155], v5 offset:4096
    ds_read_b64_tr_b16 v[156:157], v6 offset:0
    v_mfma_f32_16x16x32_f16 v[24:27], v[68:71], v[76:79], v[24:27]
    ds_read_b64_tr_b16 v[158:159], v6 offset:512
    ds_read_b64_tr_b16 v[160:161], v7 offset:0
    v_mfma_f32_16x16x32_f16 v[28:31], v[68:71], v[80:83], v[28:31]
    ds_read_b64_tr_b16 v[162:163], v7 offset:512
    ds_read_b128 v[164:167], v8 offset:0
    v_mfma_f32_16x16x32_f16 v[32:35], v[72:75], v[76:79], v[32:35]
    ds_read_b128 v[168:171], v8 offset:2048
    ds_read_b128 v[172:175], v8 offset:4096
    v_mfma_f32_16x16x32_f16 v[36:39], v[72:75], v[80:83], v[36:39]
    ds_read_b64_tr_b16 v[176:177], v6 offset:4096
    ds_read_b64_tr_b16 v[178:179], v6 offset:4608
    v_mfma_f32_16x16x32_f16 v[16:19], v[84:87], v[96:99], v[16:19]
    ds_read_b64_tr_b16 v[180:181], v7 offset:4096
    ds_read_b64_tr_b16 v[182:183], v7 offset:4608
    v_mfma_f32_16x16x32_f16 v[20:23], v[84:87], v[100:103], v[20:23]
    v_mfma_f32_16x16x32_f16 v[24:27], v[88:91], v[96:99], v[24:27]
    v_mfma_f32_16x16x32_f16 v[28:31], v[88:91], v[100:103], v[28:31]
    v_mfma_f32_16x16x32_f16 v[32:35], v[92:95], v[96:99], v[32:35]
    v_mfma_f32_16x16x32_f16 v[36:39], v[92:95], v[100:103], v[36:39]
    s_add_u32 s52, s52, 17408
    s_cmp_ge_u32 s52, 156672
    s_cselect_b32 s52, 0, s52
    v_add_u32 v5, s52, v2
    v_add_u32 v6, s52, v3
    v_add_u32 v7, s52, v4
    v_xor_b32 v8, 64, v5
    s_waitcnt lgkmcnt(14)
    s_barrier
    v_mfma_f32_16x16x32_f16 v[16:19], v[104:107], v[116:119], v[16:19]
    ds_read_b128 v[64:67], v5 offset:0
    ds_read_b128 v[68:71], v5 offset:2048
    v_mfma_f32_16x16x32_f16 v[20:23], v[104:107], v[120:123], v[20:23]
    ds_read_b128 v[72:75], v5 offset:4096
    ds_read_b64_tr_b16 v[76:77], v6 offset:0
    v_mfma_f32_16x16x32_f16 v[24:27], v[108:111], v[116:119], v[24:27]
    ds_read_b64_tr_b16 v[78:79], v6 offset:512
    ds_read_b64_tr_b16 v[80:81], v7 offset:0
    v_mfma_f32_16x16x32_f16 v[28:31], v[108:111], v[120:123], v[28:31]
    ds_read_b64_tr_b16 v[82:83], v7 offset:512
    ds_read_b128 v[84:87], v8 offset:0
    v_mfma_f32_16x16x32_f16 v[32:35], v[112:115], v[116:119], v[32:35]
    ds_read_b128 v[88:91], v8 offset:2048
    ds_read_b128 v[92:95], v8 offset:4096
    v_mfma_f32_16x16x32_f16 v[36:39], v[112:115], v[120:123], v[36:39]
    ds_read_b64_tr_b16 v[96:97], v6 offset:4096
    ds_read_b64_tr_b16 v[98:99], v6 offset:4608
    v_mfma_f32_16x16x32_f16 v[16:19], v[124:127], v[136:139], v[16:19]
    ds_read_b64_tr_b16 v[100:101], v7 offset:4096
    ds_read_b64_tr_b16 v[102:103], v7 offset:4608
    v_mfma_f32_16x16x32_f16 v[20:23], v[124:127], v[140:143], v[20:23]
    v_mfma_f32_16x16x32_f16 v[24:27], v[128:131], v[136:139], v[24:27]
    v_mfma_f32_16x16x32_f16 v[28:31], v[128:131], v[140:143], v[28:31]
    v_mfma_f32_16x16x32_f16 v[32:35], v[132:135], v[136:139], v[32:35]
    v_mfma_f32_16x16x32_f16 v[36:39], v[132:135], v[140:143], v[36:39]
    s_add_u32 s52, s52, 17408
    s_cmp_ge_u32 s52, 156672
    s_cselect_b32 s52, 0, s52
    v_add_u32 v5, s52, v2
    v_add_u32 v6, s52, v3
    v_add_u32 v7, s52, v4
    v_xor_b32 v8, 64, v5
    s_waitcnt lgkmcnt(14)
    s_barrier
    v_mfma_f32_16x16x32_f16 v[16:19], v[144:147], v[156:159], v[16:19]
    ds_read_b128 v[104:107], v5 offset:0
    ds_read_b128 v[108:111], v5 offset:2048
    v_mfma_f32_16x16x32_f16 v[20:23], v[144:147], v[160:163], v[20:23]
    ds_read_b128 v[112:115], v5 offset:4096
    ds_read_b64_tr_b16 v[116:117], v6 offset:0
    v_mfma_f32_16x16x32_f16 v[24:27], v[148:151], v[156:159], v[24:27]
    ds_read_b64_tr_b16 v[118:119], v6 offset:512
    ds_read_b64_tr_b16 v[120:121], v7 offset:0
    v_mfma_f32_16x16x32_f16 v[28:31], v[148:151], v[160:163], v[28:31]
    ds_read_b64_tr_b16 v[122:123], v7 offset:512
    ds_read_b128 v[124:127], v8 offset:0
    v_mfma_f32_16x16x32_f16 v[32:35], v[152:155], v[156:159], v[32:35]
    ds_read_b128 v[128:131], v8 offset:2048
    ds_read_b128 v[132:135], v8 offset:4096
    v_mfma_f32_16x16x32_f16 v[36:39], v[152:155], v[160:163], v[36:39]
    ds_read_b64_tr_b16 v[136:137], v6 offset:4096
    ds_read_b64_tr_b16 v[138:139], v6 offset:4608
    v_mfma_f32_16x16x32_f16 v[16:19], v[164:167], v[176:179], v[16:19]
    ds_read_b64_tr_b16 v[140:141], v7 offset:4096
    ds_read_b64_tr_b16 v[142:143], v7 offset:4608
    v_mfma_f32_16x16x32_f16 v[20:23], v[164:167], v[180:183], v[20:23]
    v_mfma_f32_16x16x32_f16 v[24:27], v[168:171], v[176:179], v[24:27]
    v_mfma_f32_16x16x32_f16 v[28:31], v[168:171], v[180:183], v[28:31]
    v_mfma_f32_16x16x32_f16 v[32:35], v[172:175], v[176:179], v[32:35]
    v_mfma_f32_16x16x32_f16 v[36:39], v[172:175], v[180:183], v[36:39]
    s_add_u32 s53, s53, 1
    s_cmp_lt_u32 s53, 2
    s_cbranch_scc1 K3_LA0
    s_add_u32 s52, s52, 17408
    s_cmp_ge_u32 s52, 156672
    s_cselect_b32 s52, 0, s52
    v_add_u32 v5, s52, v2
    v_add_u32 v6, s52, v3
    v_add_u32 v7, s52, v4
    v_xor_b32 v8, 64, v5
    s_waitcnt lgkmcnt(14)
    s_barrier
    v_mfma_f32_16x16x32_bf16 v[40:43], v[64:67], v[76:79], 0
    ds_read_b128 v[144:147], v5 offset:0
    ds_read_b128 v[148:151], v5 offset:2048
    v_mfma_f32_16x16x32_bf16 v[44:47], v[64:67], v[80:83], 0
    ds_read_b128 v[152:155], v5 offset:4096
    ds_read_b64_tr_b16 v[156:157], v6 offset:0
    v_mfma_f32_16x16x32_bf16 v[48:51], v[68:71], v[76:79], 0
    ds_read_b64_tr_b16 v[158:159], v6 offset:512
    ds_read_b64_tr_b16 v[160:161], v7 offset:0
    v_mfma_f32_16x16x32_bf16 v[52:55], v[68:71], v[80:83], 0
    ds_read_b64_tr_b16 v[162:163], v7 offset:512
    ds_read_b128 v[164:167], v8 offset:0
    v_mfma_f32_16x16x32_bf16 v[56:59], v[72:75], v[76:79], 0
    ds_read_b128 v[168:171], v8 offset:2048
    ds_read_b128 v[172:175], v8 offset:4096
    v_mfma_f32_16x16x32_bf16 v[60:63], v[72:75], v[80:83], 0
    ds_read_b64_tr_b16 v[176:177], v6 offset:4096
    ds_read_b64_tr_b16 v[178:179], v6 offset:4608
    v_mfma_f32_16x16x32_bf16 v[40:43], v[84:87], v[96:99], v[40:43]
    ds_read_b64_tr_b16 v[180:181], v7 offset:4096
    ds_read_b64_tr_b16 v[182:183], v7 offset:4608
    v_mfma_f32_16x16x32_bf16 v[44:47], v[84:87], v[100:103], v[44:47]
    v_mfma_f32_16x16x32_bf16 v[48:51], v[88:91], v[96:99], v[48:51]
    v_mfma_f32_16x16x32_bf16 v[52:55], v[88:91], v[100:103], v[52:55]
    v_mfma_f32_16x16x32_bf16 v[56:59], v[92:95], v[96:99], v[56:59]
    v_mfma_f32_16x16x32_bf16 v[60:63], v[92:95], v[100:103], v[60:63]
    s_add_u32 s52, s52, 17408
    s_cmp_ge_u32 s52, 156672
    s_cselect_b32 s52, 0, s52
    v_add_u32 v5, s52, v2
    v_add_u32 v6, s52, v3
    v_add_u32 v7, s52, v4
    v_xor_b32 v8, 64, v5
    s_waitcnt lgkmcnt(14)
    s_barrier
    v_mfma_f32_16x16x32_bf16 v[40:43], v[104:107], v[116:119], v[40:43]
    ds_read_b128 v[64:67], v5 offset:0
    ds_read_b128 v[68:71], v5 offset:2048
    v_mfma_f32_16x16x32_bf16 v[44:47], v[104:107], v[120:123], v[44:47]
    ds_read_b128 v[72:75], v5 offset:4096
    ds_read_b64_tr_b16 v[76:77], v6 offset:0
    v_mfma_f32_16x16x32_bf16 v[48:51], v[108:111], v[116:119], v[48:51]
    ds_read_b64_tr_b16 v[78:79], v6 offset:512
    ds_read_b64_tr_b16 v[80:81], v7 offset:0
    v_mfma_f32_16x16x32_bf16 v[52:55], v[108:111], v[120:123], v[52:55]
    ds_read_b64_tr_b16 v[82:83], v7 offset:512
    ds_read_b128 v[84:87], v8 offset:0
    v_mfma_f32_16x16x32_bf16 v[56:59], v[112:115], v[116:119], v[56:59]
    ds_read_b128 v[88:91], v8 offset:2048
    ds_read_b128 v[92:95], v8 offset:4096
    v_mfma_f32_16x16x32_bf16 v[60:63], v[112:115], v[120:123], v[60:63]
    ds_read_b64_tr_b16 v[96:97], v6 offset:4096
    ds_read_b64_tr_b16 v[98:99], v6 offset:4608
    v_mfma_f32_16x16x32_bf16 v[40:43], v[124:127], v[136:139], v[40:43]
    ds_read_b64_tr_b16 v[100:101], v7 offset:4096
    ds_read_b64_tr_b16 v[102:103], v7 offset:4608
    v_mfma_f32_16x16x32_bf16 v[44:47], v[124:127], v[140:143], v[44:47]
    v_mfma_f32_16x16x32_bf16 v[48:51], v[128:131], v[136:139], v[48:51]
    v_mfma_f32_16x16x32_bf16 v[52:55], v[128:131], v[140:143], v[52:55]
    v_mfma_f32_16x16x32_bf16 v[56:59], v[132:135], v[136:139], v[56:59]
    v_mfma_f32_16x16x32_bf16 v[60:63], v[132:135], v[140:143], v[60:63]
    s_add_u32 s52, s52, 17408
    s_cmp_ge_u32 s52, 156672
    s_cselect_b32 s52, 0, s52
    v_add_u32 v5, s52, v2
    v_add_u32 v6, s52, v3
    v_add_u32 v7, s52, v4
    v_xor_b32 v8, 64, v5
    s_waitcnt lgkmcnt(14)
    s_barrier
    v_mfma_f32_16x16x32_bf16 v[40:43], v[144:147], v[156:159], v[40:43]
    ds_read_b128 v[104:107], v5 offset:0
    ds_read_b128 v[108:111], v5 offset:2048
    v_mfma_f32_16x16x32_bf16 v[44:47], v[144:147], v[160:163], v[44:47]
    ds_read_b128 v[112:115], v5 offset:4096
    ds_read_b64_tr_b16 v[116:117], v6 offset:0
    v_mfma_f32_16x16x32_bf16 v[48:51], v[148:151], v[156:159], v[48:51]
    ds_read_b64_tr_b16 v[118:119], v6 offset:512
    ds_read_b64_tr_b16 v[120:121], v7 offset:0
    v_mfma_f32_16x16x32_bf16 v[52:55], v[148:151], v[160:163], v[52:55]
    ds_read_b64_tr_b16 v[122:123], v7 offset:512
    ds_read_b128 v[124:127], v8 offset:0
    v_mfma_f32_16x16x32_bf16 v[56:59], v[152:155], v[156:159], v[56:59]
    ds_read_b128 v[128:131], v8 offset:2048
    ds_read_b128 v[132:135], v8 offset:4096
    v_mfma_f32_16x16x32_bf16 v[60:63], v[152:155], v[160:163], v[60:63]
    ds_read_b64_tr_b16 v[136:137], v6 offset:4096
    ds_read_b64_tr_b16 v[138:139], v6 offset:4608
    v_mfma_f32_16x16x32_bf16 v[40:43], v[164:167], v[176:179], v[40:43]
    ds_read_b64_tr_b16 v[140:141], v7 offset:4096
    ds_read_b64_tr_b16 v[142:143], v7 offset:4608
    v_mfma_f32_16x16x32_bf16 v[44:47], v[164:167], v[180:183], v[44:47]
    v_mfma_f32_16x16x32_bf16 v[48:51], v[168:171], v[176:179], v[48:51]
    v_mfma_f32_16x16x32_bf16 v[52:55], v[168:171], v[180:183], v[52:55]
    v_mfma_f32_16x16x32_bf16 v[56:59], v[172:175], v[176:179], v[56:59]
    v_mfma_f32_16x16x32_bf16 v[60:63], v[172:175], v[180:183], v[60:63]
    s_mov_b32 s53, 0
K3_LB0:
    s_add_u32 s52, s52, 17408
    s_cmp_ge_u32 s52, 156672
    s_cselect_b32 s52, 0, s52
    v_add_u32 v5, s52, v2
    v_add_u32 v6, s52, v3
    v_add_u32 v7, s52, v4
    v_xor_b32 v8, 64, v5
    s_waitcnt lgkmcnt(14)
    s_barrier
    v_mfma_f32_16x16x32_bf16 v[40:43], v[64:67], v[76:79], v[40:43]
    ds_read_b128 v[144:147], v5 offset:0
    ds_read_b128 v[148:151], v5 offset:2048
    v_mfma_f32_16x16x32_bf16 v[44:47], v[64:67], v[80:83], v[44:47]
    ds_read_b128 v[152:155], v5 offset:4096
    ds_read_b64_tr_b16 v[156:157], v6 offset:0
    v_mfma_f32_16x16x32_bf16 v[48:51], v[68:71], v[76:79], v[48:51]
    ds_read_b64_tr_b16 v[158:159], v6 offset:512
    ds_read_b64_tr_b16 v[160:161], v7 offset:0
    v_mfma_f32_16x16x32_bf16 v[52:55], v[68:71], v[80:83], v[52:55]
    ds_read_b64_tr_b16 v[162:163], v7 offset:512
    ds_read_b128 v[164:167], v8 offset:0
    v_mfma_f32_16x16x32_bf16 v[56:59], v[72:75], v[76:79], v[56:59]
    ds_read_b128 v[168:171], v8 offset:2048
    ds_read_b128 v[172:175], v8 offset:4096
    v_mfma_f32_16x16x32_bf16 v[60:63], v[72:75], v[80:83], v[60:63]
    ds_read_b64_tr_b16 v[176:177], v6 offset:4096
    ds_read_b64_tr_b16 v[178:179], v6 offset:4608
    v_mfma_f32_16x16x32_bf16 v[40:43], v[84:87], v[96:99], v[40:43]
    ds_read_b64_tr_b16 v[180:181], v7 offset:4096
    ds_read_b64_tr_b16 v[182:183], v7 offset:4608
    v_mfma_f32_16x16x32_bf16 v[44:47], v[84:87], v[100:103], v[44:47]
    v_mfma_f32_16x16x32_bf16 v[48:51], v[88:91], v[96:99], v[48:51]
    v_mfma_f32_16x16x32_bf16 v[52:55], v[88:91], v[100:103], v[52:55]
    v_mfma_f32_16x16x32_bf16 v[56:59], v[92:95], v[96:99], v[56:59]
    v_mfma_f32_16x16x32_bf16 v[60:63], v[92:95], v[100:103], v[60:63]
    s_add_u32 s52, s52, 17408
    s_cmp_ge_u32 s52, 156672
    s_cselect_b32 s52, 0, s52
    v_add_u32 v5, s52, v2
    v_add_u32 v6, s52, v3
    v_add_u32 v7, s52, v4
    v_xor_b32 v8, 64, v5
    s_waitcnt lgkmcnt(14)
    s_barrier
    v_mfma_f32_16x16x32_bf16 v[40:43], v[104:107], v[116:119], v[40:43]
    ds_read_b128 v[64:67], v5 offset:0
    ds_read_b128 v[68:71], v5 offset:2048
    v_mfma_f32_16x16x32_bf16 v[44:47], v[104:107], v[120:123], v[44:47]
    ds_read_b128 v[72:75], v5 offset:4096
    ds_read_b64_tr_b16 v[76:77], v6 offset:0
    v_mfma_f32_16x16x32_bf16 v[48:51], v[108:111], v[116:119], v[48:51]
    ds_read_b64_tr_b16 v[78:79], v6 offset:512
    ds_read_b64_tr_b16 v[80:81], v7 offset:0
    v_mfma_f32_16x16x32_bf16 v[52:55], v[108:111], v[120:123], v[52:55]
    ds_read_b64_tr_b16 v[82:83], v7 offset:512
    ds_read_b128 v[84:87], v8 offset:0
    v_mfma_f32_16x16x32_bf16 v[56:59], v[112:115], v[116:119], v[56:59]
    ds_read_b128 v[88:91], v8 offset:2048
    ds_read_b128 v[92:95], v8 offset:4096
    v_mfma_f32_16x16x32_bf16 v[60:63], v[112:115], v[120:123], v[60:63]
    ds_read_b64_tr_b16 v[96:97], v6 offset:4096
    ds_read_b64_tr_b16 v[98:99], v6 offset:4608
    v_mfma_f32_16x16x32_bf16 v[40:43], v[124:127], v[136:139], v[40:43]
    ds_read_b64_tr_b16 v[100:101], v7 offset:4096
    ds_read_b64_tr_b16 v[102:103], v7 offset:4608
    v_mfma_f32_16x16x32_bf16 v[44:47], v[124:127], v[140:143], v[44:47]
    v_mfma_f32_16x16x32_bf16 v[48:51], v[128:131], v[136:139], v[48:51]
    v_mfma_f32_16x16x32_bf16 v[52:55], v[128:131], v[140:143], v[52:55]
    v_mfma_f32_16x16x32_bf16 v[56:59], v[132:135], v[136:139], v[56:59]
    v_mfma_f32_16x16x32_bf16 v[60:63], v[132:135], v[140:143], v[60:63]
    s_add_u32 s52, s52, 17408
    s_cmp_ge_u32 s52, 156672
    s_cselect_b32 s52, 0, s52
    v_add_u32 v5, s52, v2
    v_add_u32 v6, s52, v3
    v_add_u32 v7, s52, v4
    v_xor_b32 v8, 64, v5
    s_waitcnt lgkmcnt(14)
    s_barrier
    v_mfma_f32_16x16x32_bf16 v[40:43], v[144:147], v[156:159], v[40:43]
    ds_read_b128 v[104:107], v5 offset:0
    ds_read_b128 v[108:111], v5 offset:2048
    v_mfma_f32_16x16x32_bf16 v[44:47], v[144:147], v[160:163], v[44:47]
    ds_read_b128 v[112:115], v5 offset:4096
    ds_read_b64_tr_b16 v[116:117], v6 offset:0
    v_mfma_f32_16x16x32_bf16 v[48:51], v[148:151], v[156:159], v[48:51]
    ds_read_b64_tr_b16 v[118:119], v6 offset:512
    ds_read_b64_tr_b16 v[120:121], v7 offset:0
    v_mfma_f32_16x16x32_bf16 v[52:55], v[148:151], v[160:163], v[52:55]
    ds_read_b64_tr_b16 v[122:123], v7 offset:512
    ds_read_b128 v[124:127], v8 offset:0
    v_mfma_f32_16x16x32_bf16 v[56:59], v[152:155], v[156:159], v[56:59]
    ds_read_b128 v[128:131], v8 offset:2048
    ds_read_b128 v[132:135], v8 offset:4096
    v_mfma_f32_16x16x32_bf16 v[60:63], v[152:155], v[160:163], v[60:63]
    ds_read_b64_tr_b16 v[136:137], v6 offset:4096
    ds_read_b64_tr_b16 v[138:139], v6 offset:4608
    v_mfma_f32_16x16x32_bf16 v[40:43], v[164:167], v[176:179], v[40:43]
    ds_read_b64_tr_b16 v[140:141], v7 offset:4096
    ds_read_b64_tr_b16 v[142:143], v7 offset:4608
    v_mfma_f32_16x16x32_bf16 v[44:47], v[164:167], v[180:183], v[44:47]
    v_mfma_f32_16x16x32_bf16 v[48:51], v[168:171], v[176:179], v[48:51]
    v_mfma_f32_16x16x32_bf16 v[52:55], v[168:171], v[180:183], v[52:55]
    v_mfma_f32_16x16x32_bf16 v[56:59], v[172:175], v[176:179], v[56:59]
    v_mfma_f32_16x16x32_bf16 v[60:63], v[172:175], v[180:183], v[60:63]
    s_add_u32 s53, s53, 1
    s_cmp_lt_u32 s53, 22
    s_cbranch_scc1 K3_LB0
    s_add_u32 s52, s52, 17408
    s_cmp_ge_u32 s52, 156672
    s_cselect_b32 s52, 0, s52
    v_add_u32 v5, s52, v2
    v_add_u32 v6, s52, v3
    v_add_u32 v7, s52, v4
    v_xor_b32 v8, 64, v5
    s_waitcnt lgkmcnt(14)
    s_barrier
    v_mfma_f32_16x16x32_bf16 v[40:43], v[64:67], v[76:79], v[40:43]
    ds_read_b128 v[144:147], v5 offset:0
    ds_read_b128 v[148:151], v5 offset:2048
    v_mfma_f32_16x16x32_bf16 v[44:47], v[64:67], v[80:83], v[44:47]
    ds_read_b128 v[152:155], v5 offset:4096
    ds_read_b64_tr_b16 v[156:157], v6 offset:0
    v_mfma_f32_16x16x32_bf16 v[48:51], v[68:71], v[76:79], v[48:51]
    ds_read_b64_tr_b16 v[158:159], v6 offset:512
    ds_read_b64_tr_b16 v[160:161], v7 offset:0
    v_mfma_f32_16x16x32_bf16 v[52:55], v[68:71], v[80:83], v[52:55]
    ds_read_b64_tr_b16 v[162:163], v7 offset:512
    ds_read_b128 v[164:167], v8 offset:0
    v_mfma_f32_16x16x32_bf16 v[56:59], v[72:75], v[76:79], v[56:59]
    ds_read_b128 v[168:171], v8 offset:2048
    ds_read_b128 v[172:175], v8 offset:4096
    v_mfma_f32_16x16x32_bf16 v[60:63], v[72:75], v[80:83], v[60:63]
    ds_read_b64_tr_b16 v[176:177], v6 offset:4096
    ds_read_b64_tr_b16 v[178:179], v6 offset:4608
    v_mfma_f32_16x16x32_bf16 v[40:43], v[84:87], v[96:99], v[40:43]
    ds_read_b64_tr_b16 v[180:181], v7 offset:4096
    ds_read_b64_tr_b16 v[182:183], v7 offset:4608
    v_mfma_f32_16x16x32_bf16 v[44:47], v[84:87], v[100:103], v[44:47]
    v_mfma_f32_16x16x32_bf16 v[48:51], v[88:91], v[96:99], v[48:51]
    v_mfma_f32_16x16x32_bf16 v[52:55], v[88:91], v[100:103], v[52:55]
    v_mfma_f32_16x16x32_bf16 v[56:59], v[92:95], v[96:99], v[56:59]
    v_mfma_f32_16x16x32_bf16 v[60:63], v[92:95], v[100:103], v[60:63]
    s_add_u32 s52, s52, 17408
    s_cmp_ge_u32 s52, 156672
    s_cselect_b32 s52, 0, s52
    v_add_u32 v5, s52, v2
    v_add_u32 v6, s52, v3
    v_add_u32 v7, s52, v4
    v_xor_b32 v8, 64, v5
    s_waitcnt lgkmcnt(14)
    s_barrier
    v_mfma_f32_16x16x32_bf16 v[40:43], v[104:107], v[116:119], v[40:43]
    ds_read_b128 v[64:67], v5 offset:0
    ds_read_b128 v[68:71], v5 offset:2048
    v_mfma_f32_16x16x32_bf16 v[44:47], v[104:107], v[120:123], v[44:47]
    ds_read_b128 v[72:75], v5 offset:4096
    ds_read_b64_tr_b16 v[76:77], v6 offset:0
    v_mfma_f32_16x16x32_bf16 v[48:51], v[108:111], v[116:119], v[48:51]
    ds_read_b64_tr_b16 v[78:79], v6 offset:512
    ds_read_b64_tr_b16 v[80:81], v7 offset:0
    v_mfma_f32_16x16x32_bf16 v[52:55], v[108:111], v[120:123], v[52:55]
    ds_read_b64_tr_b16 v[82:83], v7 offset:512
    ds_read_b128 v[84:87], v8 offset:0
    v_mfma_f32_16x16x32_bf16 v[56:59], v[112:115], v[116:119], v[56:59]
    ds_read_b128 v[88:91], v8 offset:2048
    ds_read_b128 v[92:95], v8 offset:4096
    v_mfma_f32_16x16x32_bf16 v[60:63], v[112:115], v[120:123], v[60:63]
    ds_read_b64_tr_b16 v[96:97], v6 offset:4096
    ds_read_b64_tr_b16 v[98:99], v6 offset:4608
    v_mfma_f32_16x16x32_bf16 v[40:43], v[124:127], v[136:139], v[40:43]
    ds_read_b64_tr_b16 v[100:101], v7 offset:4096
    ds_read_b64_tr_b16 v[102:103], v7 offset:4608
    v_mfma_f32_16x16x32_bf16 v[44:47], v[124:127], v[140:143], v[44:47]
    v_mfma_f32_16x16x32_bf16 v[48:51], v[128:131], v[136:139], v[48:51]
    v_mfma_f32_16x16x32_bf16 v[52:55], v[128:131], v[140:143], v[52:55]
    v_mfma_f32_16x16x32_bf16 v[56:59], v[132:135], v[136:139], v[56:59]
    v_mfma_f32_16x16x32_bf16 v[60:63], v[132:135], v[140:143], v[60:63]
    v_and_b32 v9, 15, v1
    v_lshrrev_b32 v10, 4, v1
    v_mul_u32_u24 v11, 1152, v9
    v_lshl_add_u32 v11, v10, 3, v11
    s_lshl_b32 s54, s36, 6
    s_lshl_b32 s55, s41, 5
    s_add_u32 s54, s54, s55
    s_mul_i32 s54, s54, 1152
    s_lshl_b32 s55, s39, 1
    s_add_u32 s54, s54, s55
    s_add_u32 s54, s54, 0
    s_add_u32 s55, s54, 0
    buffer_load_dwordx2 v[200:201], v11, s[20:23], s55 offen
    s_add_u32 s55, s54, 18432
    buffer_load_dwordx2 v[202:203], v11, s[20:23], s55 offen
    s_add_u32 s55, s54, 32
    buffer_load_dwordx2 v[204:205], v11, s[20:23], s55 offen
    s_add_u32 s55, s54, 18464
    buffer_load_dwordx2 v[206:207], v11, s[20:23], s55 offen
    s_add_u32 s55, s54, 64
    buffer_load_dwordx2 v[208:209], v11, s[20:23], s55 offen
    s_add_u32 s55, s54, 18496
    buffer_load_dwordx2 v[210:211], v11, s[20:23], s55 offen
    v_lshlrev_b32 v12, 1, v9
    s_lshl_b32 s55, s41, 6
    s_add_u32 s55, s55, s38
    buffer_load_ushort v220, v12, s[32:35], s55 offen offset:0
    buffer_load_ushort v221, v12, s[32:35], s55 offen offset:32
    s_add_u32 s52, s52, 17408
    s_cmp_ge_u32 s52, 156672
    s_cselect_b32 s52, 0, s52
    v_add_u32 v5, s52, v2
    v_add_u32 v6, s52, v3
    v_add_u32 v7, s52, v4
    v_xor_b32 v8, 64, v5
    s_waitcnt lgkmcnt(14)
    s_barrier
    v_mfma_f32_16x16x32_bf16 v[40:43], v[144:147], v[156:159], v[40:43]
    ds_read_b128 v[104:107], v5 offset:0
    ds_read_b128 v[108:111], v5 offset:2048
    v_mfma_f32_16x16x32_bf16 v[44:47], v[144:147], v[160:163], v[44:47]
    ds_read_b128 v[112:115], v5 offset:4096
    ds_read_b64_tr_b16 v[116:117], v6 offset:0
    v_mfma_f32_16x16x32_bf16 v[48:51], v[148:151], v[156:159], v[48:51]
    ds_read_b64_tr_b16 v[118:119], v6 offset:512
    ds_read_b64_tr_b16 v[120:121], v7 offset:0
    v_mfma_f32_16x16x32_bf16 v[52:55], v[148:151], v[160:163], v[52:55]
    ds_read_b64_tr_b16 v[122:123], v7 offset:512
    ds_read_b128 v[124:127], v8 offset:0
    v_mfma_f32_16x16x32_bf16 v[56:59], v[152:155], v[156:159], v[56:59]
    ds_read_b128 v[128:131], v8 offset:2048
    ds_read_b128 v[132:135], v8 offset:4096
    v_mfma_f32_16x16x32_bf16 v[60:63], v[152:155], v[160:163], v[60:63]
    ds_read_b64_tr_b16 v[136:137], v6 offset:4096
    ds_read_b64_tr_b16 v[138:139], v6 offset:4608
    v_mfma_f32_16x16x32_bf16 v[40:43], v[164:167], v[176:179], v[40:43]
    ds_read_b64_tr_b16 v[140:141], v7 offset:4096
    ds_read_b64_tr_b16 v[142:143], v7 offset:4608
    v_mfma_f32_16x16x32_bf16 v[44:47], v[164:167], v[180:183], v[44:47]
    v_mfma_f32_16x16x32_bf16 v[48:51], v[168:171], v[176:179], v[48:51]
    v_mfma_f32_16x16x32_bf16 v[52:55], v[168:171], v[180:183], v[52:55]
    v_mfma_f32_16x16x32_bf16 v[56:59], v[172:175], v[176:179], v[56:59]
    v_mfma_f32_16x16x32_bf16 v[60:63], v[172:175], v[180:183], v[60:63]
    s_waitcnt vmcnt(0)
    v_lshlrev_b32 v220, 16, v220
    v_lshlrev_b32 v221, 16, v221
    v_cvt_pk_bf16_f32 v224, v16, v17
    v_cvt_pk_bf16_f32 v225, v18, v19
    v_cvt_pk_bf16_f32 v226, v40, v41
    v_cvt_pk_bf16_f32 v227, v42, v43
    v_lshlrev_b32 v16, 16, v224
    v_and_b32 v17, 0xffff0000, v224
    v_lshlrev_b32 v18, 16, v225
    v_and_b32 v19, 0xffff0000, v225
    v_lshlrev_b32 v40, 16, v226
    v_and_b32 v41, 0xffff0000, v226
    v_lshlrev_b32 v42, 16, v227
    v_and_b32 v43, 0xffff0000, v227
    v_lshlrev_b32 v228, 16, v200
    v_and_b32 v229, 0xffff0000, v200
    v_lshlrev_b32 v230, 16, v201
    v_and_b32 v231, 0xffff0000, v201
    v_pk_add_f32 v[16:17], v[16:17], v[228:229]
    v_pk_add_f32 v[18:19], v[18:19], v[230:231]
    v_add_f32 v40, v40, v220
    v_add_f32 v41, v41, v220
    v_add_f32 v42, v42, v220
    v_add_f32 v43, v43, v220
    v_cvt_pk_bf16_f32 v224, v16, v17
    v_cvt_pk_bf16_f32 v225, v18, v19
    v_cvt_pk_bf16_f32 v226, v40, v41
    v_cvt_pk_bf16_f32 v227, v42, v43
    v_lshlrev_b32 v16, 16, v224
    v_and_b32 v17, 0xffff0000, v224
    v_lshlrev_b32 v18, 16, v225
    v_and_b32 v19, 0xffff0000, v225
    v_lshlrev_b32 v40, 16, v226
    v_and_b32 v41, 0xffff0000, v226
    v_lshlrev_b32 v42, 16, v227
    v_and_b32 v43, 0xffff0000, v227
    v_pk_add_f32 v[16:17], v[16:17], v[40:41]
    v_pk_add_f32 v[18:19], v[18:19], v[42:43]
    v_cvt_pk_bf16_f32 v16, v16, v17
    v_cvt_pk_bf16_f32 v17, v18, v19
    s_add_u32 s55, s54, 0
    buffer_store_dwordx2 v[16:17], v11, s[24:27], s55 offen
    v_cvt_pk_bf16_f32 v224, v20, v21
    v_cvt_pk_bf16_f32 v225, v22, v23
    v_cvt_pk_bf16_f32 v226, v44, v45
    v_cvt_pk_bf16_f32 v227, v46, v47
    v_lshlrev_b32 v20, 16, v224
    v_and_b32 v21, 0xffff0000, v224
    v_lshlrev_b32 v22, 16, v225
    v_and_b32 v23, 0xffff0000, v225
    v_lshlrev_b32 v44, 16, v226
    v_and_b32 v45, 0xffff0000, v226
    v_lshlrev_b32 v46, 16, v227
    v_and_b32 v47, 0xffff0000, v227
    v_lshlrev_b32 v228, 16, v202
    v_and_b32 v229, 0xffff0000, v202
    v_lshlrev_b32 v230, 16, v203
    v_and_b32 v231, 0xffff0000, v203
    v_pk_add_f32 v[20:21], v[20:21], v[228:229]
    v_pk_add_f32 v[22:23], v[22:23], v[230:231]
    v_add_f32 v44, v44, v221
    v_add_f32 v45, v45, v221
    v_add_f32 v46, v46, v221
    v_add_f32 v47, v47, v221
    v_cvt_pk_bf16_f32 v224, v20, v21
    v_cvt_pk_bf16_f32 v225, v22, v23
    v_cvt_pk_bf16_f32 v226, v44, v45
    v_cvt_pk_bf16_f32 v227, v46, v47
    v_lshlrev_b32 v20, 16, v224
    v_and_b32 v21, 0xffff0000, v224
    v_lshlrev_b32 v22, 16, v225
    v_and_b32 v23, 0xffff0000, v225
    v_lshlrev_b32 v44, 16, v226
    v_and_b32 v45, 0xffff0000, v226
    v_lshlrev_b32 v46, 16, v227
    v_and_b32 v47, 0xffff0000, v227
    v_pk_add_f32 v[20:21], v[20:21], v[44:45]
    v_pk_add_f32 v[22:23], v[22:23], v[46:47]
    v_cvt_pk_bf16_f32 v20, v20, v21
    v_cvt_pk_bf16_f32 v21, v22, v23
    s_add_u32 s55, s54, 18432
    buffer_store_dwordx2 v[20:21], v11, s[24:27], s55 offen
    v_cvt_pk_bf16_f32 v224, v24, v25
    v_cvt_pk_bf16_f32 v225, v26, v27
    v_cvt_pk_bf16_f32 v226, v48, v49
    v_cvt_pk_bf16_f32 v227, v50, v51
    v_lshlrev_b32 v24, 16, v224
    v_and_b32 v25, 0xffff0000, v224
    v_lshlrev_b32 v26, 16, v225
    v_and_b32 v27, 0xffff0000, v225
    v_lshlrev_b32 v48, 16, v226
    v_and_b32 v49, 0xffff0000, v226
    v_lshlrev_b32 v50, 16, v227
    v_and_b32 v51, 0xffff0000, v227
    v_lshlrev_b32 v228, 16, v204
    v_and_b32 v229, 0xffff0000, v204
    v_lshlrev_b32 v230, 16, v205
    v_and_b32 v231, 0xffff0000, v205
    v_pk_add_f32 v[24:25], v[24:25], v[228:229]
    v_pk_add_f32 v[26:27], v[26:27], v[230:231]
    v_add_f32 v48, v48, v220
    v_add_f32 v49, v49, v220
    v_add_f32 v50, v50, v220
    v_add_f32 v51, v51, v220
    v_cvt_pk_bf16_f32 v224, v24, v25
    v_cvt_pk_bf16_f32 v225, v26, v27
    v_cvt_pk_bf16_f32 v226, v48, v49
    v_cvt_pk_bf16_f32 v227, v50, v51
    v_lshlrev_b32 v24, 16, v224
    v_and_b32 v25, 0xffff0000, v224
    v_lshlrev_b32 v26, 16, v225
    v_and_b32 v27, 0xffff0000, v225
    v_lshlrev_b32 v48, 16, v226
    v_and_b32 v49, 0xffff0000, v226
    v_lshlrev_b32 v50, 16, v227
    v_and_b32 v51, 0xffff0000, v227
    v_pk_add_f32 v[24:25], v[24:25], v[48:49]
    v_pk_add_f32 v[26:27], v[26:27], v[50:51]
    v_cvt_pk_bf16_f32 v24, v24, v25
    v_cvt_pk_bf16_f32 v25, v26, v27
    s_add_u32 s55, s54, 32
    buffer_store_dwordx2 v[24:25], v11, s[24:27], s55 offen
    v_cvt_pk_bf16_f32 v224, v28, v29
    v_cvt_pk_bf16_f32 v225, v30, v31
    v_cvt_pk_bf16_f32 v226, v52, v53
    v_cvt_pk_bf16_f32 v227, v54, v55
    v_lshlrev_b32 v28, 16, v224
    v_and_b32 v29, 0xffff0000, v224
    v_lshlrev_b32 v30, 16, v225
    v_and_b32 v31, 0xffff0000, v225
    v_lshlrev_b32 v52, 16, v226
    v_and_b32 v53, 0xffff0000, v226
    v_lshlrev_b32 v54, 16, v227
    v_and_b32 v55, 0xffff0000, v227
    v_lshlrev_b32 v228, 16, v206
    v_and_b32 v229, 0xffff0000, v206
    v_lshlrev_b32 v230, 16, v207
    v_and_b32 v231, 0xffff0000, v207
    v_pk_add_f32 v[28:29], v[28:29], v[228:229]
    v_pk_add_f32 v[30:31], v[30:31], v[230:231]
    v_add_f32 v52, v52, v221
    v_add_f32 v53, v53, v221
    v_add_f32 v54, v54, v221
    v_add_f32 v55, v55, v221
    v_cvt_pk_bf16_f32 v224, v28, v29
    v_cvt_pk_bf16_f32 v225, v30, v31
    v_cvt_pk_bf16_f32 v226, v52, v53
    v_cvt_pk_bf16_f32 v227, v54, v55
    v_lshlrev_b32 v28, 16, v224
    v_and_b32 v29, 0xffff0000, v224
    v_lshlrev_b32 v30, 16, v225
    v_and_b32 v31, 0xffff0000, v225
    v_lshlrev_b32 v52, 16, v226
    v_and_b32 v53, 0xffff0000, v226
    v_lshlrev_b32 v54, 16, v227
    v_and_b32 v55, 0xffff0000, v227
    v_pk_add_f32 v[28:29], v[28:29], v[52:53]
    v_pk_add_f32 v[30:31], v[30:31], v[54:55]
    v_cvt_pk_bf16_f32 v28, v28, v29
    v_cvt_pk_bf16_f32 v29, v30, v31
    s_add_u32 s55, s54, 18464
    buffer_store_dwordx2 v[28:29], v11, s[24:27], s55 offen
    v_cvt_pk_bf16_f32 v224, v32, v33
    v_cvt_pk_bf16_f32 v225, v34, v35
    v_cvt_pk_bf16_f32 v226, v56, v57
    v_cvt_pk_bf16_f32 v227, v58, v59
    v_lshlrev_b32 v32, 16, v224
    v_and_b32 v33, 0xffff0000, v224
    v_lshlrev_b32 v34, 16, v225
    v_and_b32 v35, 0xffff0000, v225
    v_lshlrev_b32 v56, 16, v226
    v_and_b32 v57, 0xffff0000, v226
    v_lshlrev_b32 v58, 16, v227
    v_and_b32 v59, 0xffff0000, v227
    v_lshlrev_b32 v228, 16, v208
    v_and_b32 v229, 0xffff0000, v208
    v_lshlrev_b32 v230, 16, v209
    v_and_b32 v231, 0xffff0000, v209
    v_pk_add_f32 v[32:33], v[32:33], v[228:229]
    v_pk_add_f32 v[34:35], v[34:35], v[230:231]
    v_add_f32 v56, v56, v220
    v_add_f32 v57, v57, v220
    v_add_f32 v58, v58, v220
    v_add_f32 v59, v59, v220
    v_cvt_pk_bf16_f32 v224, v32, v33
    v_cvt_pk_bf16_f32 v225, v34, v35
    v_cvt_pk_bf16_f32 v226, v56, v57
    v_cvt_pk_bf16_f32 v227, v58, v59
    v_lshlrev_b32 v32, 16, v224
    v_and_b32 v33, 0xffff0000, v224
    v_lshlrev_b32 v34, 16, v225
    v_and_b32 v35, 0xffff0000, v225
    v_lshlrev_b32 v56, 16, v226
    v_and_b32 v57, 0xffff0000, v226
    v_lshlrev_b32 v58, 16, v227
    v_and_b32 v59, 0xffff0000, v227
    v_pk_add_f32 v[32:33], v[32:33], v[56:57]
    v_pk_add_f32 v[34:35], v[34:35], v[58:59]
    v_cvt_pk_bf16_f32 v32, v32, v33
    v_cvt_pk_bf16_f32 v33, v34, v35
    s_add_u32 s55, s54, 64
    buffer_store_dwordx2 v[32:33], v11, s[24:27], s55 offen
    v_cvt_pk_bf16_f32 v224, v36, v37
    v_cvt_pk_bf16_f32 v225, v38, v39
    v_cvt_pk_bf16_f32 v226, v60, v61
    v_cvt_pk_bf16_f32 v227, v62, v63
    v_lshlrev_b32 v36, 16, v224
    v_and_b32 v37, 0xffff0000, v224
    v_lshlrev_b32 v38, 16, v225
    v_and_b32 v39, 0xffff0000, v225
    v_lshlrev_b32 v60, 16, v226
    v_and_b32 v61, 0xffff0000, v226
    v_lshlrev_b32 v62, 16, v227
    v_and_b32 v63, 0xffff0000, v227
    v_lshlrev_b32 v228, 16, v210
    v_and_b32 v229, 0xffff0000, v210
    v_lshlrev_b32 v230, 16, v211
    v_and_b32 v231, 0xffff0000, v211
    v_pk_add_f32 v[36:37], v[36:37], v[228:229]
    v_pk_add_f32 v[38:39], v[38:39], v[230:231]
    v_add_f32 v60, v60, v221
    v_add_f32 v61, v61, v221
    v_add_f32 v62, v62, v221
    v_add_f32 v63, v63, v221
    v_cvt_pk_bf16_f32 v224, v36, v37
    v_cvt_pk_bf16_f32 v225, v38, v39
    v_cvt_pk_bf16_f32 v226, v60, v61
    v_cvt_pk_bf16_f32 v227, v62, v63
    v_lshlrev_b32 v36, 16, v224
    v_and_b32 v37, 0xffff0000, v224
    v_lshlrev_b32 v38, 16, v225
    v_and_b32 v39, 0xffff0000, v225
    v_lshlrev_b32 v60, 16, v226
    v_and_b32 v61, 0xffff0000, v226
    v_lshlrev_b32 v62, 16, v227
    v_and_b32 v63, 0xffff0000, v227
    v_pk_add_f32 v[36:37], v[36:37], v[60:61]
    v_pk_add_f32 v[38:39], v[38:39], v[62:63]
    v_cvt_pk_bf16_f32 v36, v36, v37
    v_cvt_pk_bf16_f32 v37, v38, v39
    s_add_u32 s55, s54, 18496
    buffer_store_dwordx2 v[36:37], v11, s[24:27], s55 offen
    s_endpgm
K3_C1:
    v_lshlrev_b32 v240, 12, v1
    s_mov_b32 s84, s8
    s_mov_b32 s85, s9
    s_mov_b32 s86, 18874368
    s_mov_b32 s87, 0x00020000
    s_and_b32 s89, s37, 7
    s_lshl_b32 s88, s89, 18
    s_add_u32 s88, s88, s38
    s_add_u32 s89, s89, 2
    s_cmp_lg_u32 s3, 1
    s_cselect_b32 s89, 1000, s89
    s_cbranch_scc1 K3_NOPF0
    buffer_load_dword v241, v240, s[84:87], s88 offen
    s_add_u32 s88, s88, 2097152
    buffer_load_dword v241, v240, s[84:87], s88 offen
    s_add_u32 s88, s88, 2097152
K3_NOPF0:
    s_mov_b32 s90, 0
    s_barrier
    s_mov_b32 s52, 0
    v_add_u32 v5, s52, v2
    v_add_u32 v6, s52, v3
    v_add_u32 v7, s52, v4
    v_xor_b32 v8, 64, v5
    ds_read_b128 v[64:67], v5 offset:0
    ds_read_b128 v[68:71], v5 offset:2048
    ds_read_b64_tr_b16 v[76:77], v6 offset:0
    ds_read_b64_tr_b16 v[78:79], v6 offset:512
    ds_read_b64_tr_b16 v[80:81], v7 offset:0
    ds_read_b64_tr_b16 v[82:83], v7 offset:512
    ds_read_b128 v[84:87], v8 offset:0
    ds_read_b128 v[88:91], v8 offset:2048
    ds_read_b64_tr_b16 v[96:97], v6 offset:4096
    ds_read_b64_tr_b16 v[98:99], v6 offset:4608
    ds_read_b64_tr_b16 v[100:101], v7 offset:4096
    ds_read_b64_tr_b16 v[102:103], v7 offset:4608
    s_add_u32 s52, s52, 17408
    s_cmp_ge_u32 s52, 156672
    s_cselect_b32 s52, 0, s52
    v_add_u32 v5, s52, v2
    v_add_u32 v6, s52, v3
    v_add_u32 v7, s52, v4
    v_xor_b32 v8, 64, v5
    ds_read_b128 v[104:107], v5 offset:0
    ds_read_b128 v[108:111], v5 offset:2048
    ds_read_b64_tr_b16 v[116:117], v6 offset:0
    ds_read_b64_tr_b16 v[118:119], v6 offset:512
    ds_read_b64_tr_b16 v[120:121], v7 offset:0
    ds_read_b64_tr_b16 v[122:123], v7 offset:512
    ds_read_b128 v[124:127], v8 offset:0
    ds_read_b128 v[128:131], v8 offset:2048
    ds_read_b64_tr_b16 v[136:137], v6 offset:4096
    ds_read_b64_tr_b16 v[138:139], v6 offset:4608
    ds_read_b64_tr_b16 v[140:141], v7 offset:4096
    ds_read_b64_tr_b16 v[142:143], v7 offset:4608
    s_add_u32 s52, s52, 17408
    s_cmp_ge_u32 s52, 156672
    s_cselect_b32 s52, 0, s52
    v_add_u32 v5, s52, v2
    v_add_u32 v6, s52, v3
    v_add_u32 v7, s52, v4
    v_xor_b32 v8, 64, v5
    s_cmp_lg_u32 s90, s89
    s_cbranch_scc1 K3_NPF1
    buffer_load_dword v241, v240, s[84:87], s88 offen
    s_add_u32 s88, s88, 2097152
    s_add_u32 s89, s89, 8
K3_NPF1:
    s_add_u32 s90, s90, 1
    s_waitcnt lgkmcnt(12)
    s_barrier
    v_mfma_f32_16x16x32_f16 v[16:19], v[64:67], v[76:79], 0
    ds_read_b128 v[144:147], v5 offset:0
    ds_read_b128 v[148:151], v5 offset:2048
    v_mfma_f32_16x16x32_f16 v[20:23], v[64:67], v[80:83], 0
    ds_read_b64_tr_b16 v[156:157], v6 offset:0
    ds_read_b64_tr_b16 v[158:159], v6 offset:512
    v_mfma_f32_16x16x32_f16 v[24:27], v[68:71], v[76:79], 0
    ds_read_b64_tr_b16 v[160:161], v7 offset:0
    ds_read_b64_tr_b16 v[162:163], v7 offset:512
    v_mfma_f32_16x16x32_f16 v[28:31], v[68:71], v[80:83], 0
    ds_read_b128 v[164:167], v8 offset:0
    ds_read_b128 v[168:171], v8 offset:2048
    v_mfma_f32_16x16x32_f16 v[16:19], v[84:87], v[96:99], v[16:19]
    ds_read_b64_tr_b16 v[176:177], v6 offset:4096
    ds_read_b64_tr_b16 v[178:179], v6 offset:4608
    v_mfma_f32_16x16x32_f16 v[20:23], v[84:87], v[100:103], v[20:23]
    ds_read_b64_tr_b16 v[180:181], v7 offset:4096
    ds_read_b64_tr_b16 v[182:183], v7 offset:4608
    v_mfma_f32_16x16x32_f16 v[24:27], v[88:91], v[96:99], v[24:27]
    v_mfma_f32_16x16x32_f16 v[28:31], v[88:91], v[100:103], v[28:31]
    s_add_u32 s52, s52, 17408
    s_cmp_ge_u32 s52, 156672
    s_cselect_b32 s52, 0, s52
    v_add_u32 v5, s52, v2
    v_add_u32 v6, s52, v3
    v_add_u32 v7, s52, v4
    v_xor_b32 v8, 64, v5
    s_cmp_lg_u32 s90, s89
    s_cbranch_scc1 K3_NPF2
    buffer_load_dword v241, v240, s[84:87], s88 offen
    s_add_u32 s88, s88, 2097152
    s_add_u32 s89, s89, 8
K3_NPF2:
    s_add_u32 s90, s90, 1
    s_waitcnt lgkmcnt(12)
    s_barrier
    v_mfma_f32_16x16x32_f16 v[16:19], v[104:107], v[116:119], v[16:19]
    ds_read_b128 v[64:67], v5 offset:0
    ds_read_b128 v[68:71], v5 offset:2048
    v_mfma_f32_16x16x32_f16 v[20:23], v[104:107], v[120:123], v[20:23]
    ds_read_b64_tr_b16 v[76:77], v6 offset:0
    ds_read_b64_tr_b16 v[78:79], v6 offset:512
    v_mfma_f32_16x16x32_f16 v[24:27], v[108:111], v[116:119], v[24:27]
    ds_read_b64_tr_b16 v[80:81], v7 offset:0
    ds_read_b64_tr_b16 v[82:83], v7 offset:512
    v_mfma_f32_16x16x32_f16 v[28:31], v[108:111], v[120:123], v[28:31]
    ds_read_b128 v[84:87], v8 offset:0
    ds_read_b128 v[88:91], v8 offset:2048
    v_mfma_f32_16x16x32_f16 v[16:19], v[124:127], v[136:139], v[16:19]
    ds_read_b64_tr_b16 v[96:97], v6 offset:4096
    ds_read_b64_tr_b16 v[98:99], v6 offset:4608
    v_mfma_f32_16x16x32_f16 v[20:23], v[124:127], v[140:143], v[20:23]
    ds_read_b64_tr_b16 v[100:101], v7 offset:4096
    ds_read_b64_tr_b16 v[102:103], v7 offset:4608
    v_mfma_f32_16x16x32_f16 v[24:27], v[128:131], v[136:139], v[24:27]
    v_mfma_f32_16x16x32_f16 v[28:31], v[128:131], v[140:143], v[28:31]
    s_add_u32 s52, s52, 17408
    s_cmp_ge_u32 s52, 156672
    s_cselect_b32 s52, 0, s52
    v_add_u32 v5, s52, v2
    v_add_u32 v6, s52, v3
    v_add_u32 v7, s52, v4
    v_xor_b32 v8, 64, v5
    s_cmp_lg_u32 s90, s89
    s_cbranch_scc1 K3_NPF3
    buffer_load_dword v241, v240, s[84:87], s88 offen
    s_add_u32 s88, s88, 2097152
    s_add_u32 s89, s89, 8
K3_NPF3:
    s_add_u32 s90, s90, 1
    s_waitcnt lgkmcnt(12)
    s_barrier
    v_mfma_f32_16x16x32_f16 v[16:19], v[144:147], v[156:159], v[16:19]
    ds_read_b128 v[104:107], v5 offset:0
    ds_read_b128 v[108:111], v5 offset:2048
    v_mfma_f32_16x16x32_f16 v[20:23], v[144:147], v[160:163], v[20:23]
    ds_read_b64_tr_b16 v[116:117], v6 offset:0
    ds_read_b64_tr_b16 v[118:119], v6 offset:512
    v_mfma_f32_16x16x32_f16 v[24:27], v[148:151], v[156:159], v[24:27]
    ds_read_b64_tr_b16 v[120:121], v7 offset:0
    ds_read_b64_tr_b16 v[122:123], v7 offset:512
    v_mfma_f32_16x16x32_f16 v[28:31], v[148:151], v[160:163], v[28:31]
    ds_read_b128 v[124:127], v8 offset:0
    ds_read_b128 v[128:131], v8 offset:2048
    v_mfma_f32_16x16x32_f16 v[16:19], v[164:167], v[176:179], v[16:19]
    ds_read_b64_tr_b16 v[136:137], v6 offset:4096
    ds_read_b64_tr_b16 v[138:139], v6 offset:4608
    v_mfma_f32_16x16x32_f16 v[20:23], v[164:167], v[180:183], v[20:23]
    ds_read_b64_tr_b16 v[140:141], v7 offset:4096
    ds_read_b64_tr_b16 v[142:143], v7 offset:4608
    v_mfma_f32_16x16x32_f16 v[24:27], v[168:171], v[176:179], v[24:27]
    v_mfma_f32_16x16x32_f16 v[28:31], v[168:171], v[180:183], v[28:31]
    s_mov_b32 s53, 0
K3_LA1:
    s_add_u32 s52, s52, 17408
    s_cmp_ge_u32 s52, 156672
    s_cselect_b32 s52, 0, s52
    v_add_u32 v5, s52, v2
    v_add_u32 v6, s52, v3
    v_add_u32 v7, s52, v4
    v_xor_b32 v8, 64, v5
    s_cmp_lg_u32 s90, s89
    s_cbranch_scc1 K3_NPF4
    buffer_load_dword v241, v240, s[84:87], s88 offen
    s_add_u32 s88, s88, 2097152
    s_add_u32 s89, s89, 8
K3_NPF4:
    s_add_u32 s90, s90, 1
    s_waitcnt lgkmcnt(12)
    s_barrier
    v_mfma_f32_16x16x32_f16 v[16:19], v[64:67], v[76:79], v[16:19]
    ds_read_b128 v[144:147], v5 offset:0
    ds_read_b128 v[148:151], v5 offset:2048
    v_mfma_f32_16x16x32_f16 v[20:23], v[64:67], v[80:83], v[20:23]
    ds_read_b64_tr_b16 v[156:157], v6 offset:0
    ds_read_b64_tr_b16 v[158:159], v6 offset:512
    v_mfma_f32_16x16x32_f16 v[24:27], v[68:71], v[76:79], v[24:27]
    ds_read_b64_tr_b16 v[160:161], v7 offset:0
    ds_read_b64_tr_b16 v[162:163], v7 offset:512
    v_mfma_f32_16x16x32_f16 v[28:31], v[68:71], v[80:83], v[28:31]
    ds_read_b128 v[164:167], v8 offset:0
    ds_read_b128 v[168:171], v8 offset:2048
    v_mfma_f32_16x16x32_f16 v[16:19], v[84:87], v[96:99], v[16:19]
    ds_read_b64_tr_b16 v[176:177], v6 offset:4096
    ds_read_b64_tr_b16 v[178:179], v6 offset:4608
    v_mfma_f32_16x16x32_f16 v[20:23], v[84:87], v[100:103], v[20:23]
    ds_read_b64_tr_b16 v[180:181], v7 offset:4096
    ds_read_b64_tr_b16 v[182:183], v7 offset:4608
    v_mfma_f32_16x16x32_f16 v[24:27], v[88:91], v[96:99], v[24:27]
    v_mfma_f32_16x16x32_f16 v[28:31], v[88:91], v[100:103], v[28:31]
    s_add_u32 s52, s52, 17408
    s_cmp_ge_u32 s52, 156672
    s_cselect_b32 s52, 0, s52
    v_add_u32 v5, s52, v2
    v_add_u32 v6, s52, v3
    v_add_u32 v7, s52, v4
    v_xor_b32 v8, 64, v5
    s_cmp_lg_u32 s90, s89
    s_cbranch_scc1 K3_NPF5
    buffer_load_dword v241, v240, s[84:87], s88 offen
    s_add_u32 s88, s88, 2097152
    s_add_u32 s89, s89, 8
K3_NPF5:
    s_add_u32 s90, s90, 1
    s_waitcnt lgkmcnt(12)
    s_barrier
    v_mfma_f32_16x16x32_f16 v[16:19], v[104:107], v[116:119], v[16:19]
    ds_read_b128 v[64:67], v5 offset:0
    ds_read_b128 v[68:71], v5 offset:2048
    v_mfma_f32_16x16x32_f16 v[20:23], v[104:107], v[120:123], v[20:23]
    ds_read_b64_tr_b16 v[76:77], v6 offset:0
    ds_read_b64_tr_b16 v[78:79], v6 offset:512
    v_mfma_f32_16x16x32_f16 v[24:27], v[108:111], v[116:119], v[24:27]
    ds_read_b64_tr_b16 v[80:81], v7 offset:0
    ds_read_b64_tr_b16 v[82:83], v7 offset:512
    v_mfma_f32_16x16x32_f16 v[28:31], v[108:111], v[120:123], v[28:31]
    ds_read_b128 v[84:87], v8 offset:0
    ds_read_b128 v[88:91], v8 offset:2048
    v_mfma_f32_16x16x32_f16 v[16:19], v[124:127], v[136:139], v[16:19]
    ds_read_b64_tr_b16 v[96:97], v6 offset:4096
    ds_read_b64_tr_b16 v[98:99], v6 offset:4608
    v_mfma_f32_16x16x32_f16 v[20:23], v[124:127], v[140:143], v[20:23]
    ds_read_b64_tr_b16 v[100:101], v7 offset:4096
    ds_read_b64_tr_b16 v[102:103], v7 offset:4608
    v_mfma_f32_16x16x32_f16 v[24:27], v[128:131], v[136:139], v[24:27]
    v_mfma_f32_16x16x32_f16 v[28:31], v[128:131], v[140:143], v[28:31]
    s_add_u32 s52, s52, 17408
    s_cmp_ge_u32 s52, 156672
    s_cselect_b32 s52, 0, s52
    v_add_u32 v5, s52, v2
    v_add_u32 v6, s52, v3
    v_add_u32 v7, s52, v4
    v_xor_b32 v8, 64, v5
    s_cmp_lg_u32 s90, s89
    s_cbranch_scc1 K3_NPF6
    buffer_load_dword v241, v240, s[84:87], s88 offen
    s_add_u32 s88, s88, 2097152
    s_add_u32 s89, s89, 8
K3_NPF6:
    s_add_u32 s90, s90, 1
    s_waitcnt lgkmcnt(12)
    s_barrier
    v_mfma_f32_16x16x32_f16 v[16:19], v[144:147], v[156:159], v[16:19]
    ds_read_b128 v[104:107], v5 offset:0
    ds_read_b128 v[108:111], v5 offset:2048
    v_mfma_f32_16x16x32_f16 v[20:23], v[144:147], v[160:163], v[20:23]
    ds_read_b64_tr_b16 v[116:117], v6 offset:0
    ds_read_b64_tr_b16 v[118:119], v6 offset:512
    v_mfma_f32_16x16x32_f16 v[24:27], v[148:151], v[156:159], v[24:27]
    ds_read_b64_tr_b16 v[120:121], v7 offset:0
    ds_read_b64_tr_b16 v[122:123], v7 offset:512
    v_mfma_f32_16x16x32_f16 v[28:31], v[148:151], v[160:163], v[28:31]
    ds_read_b128 v[124:127], v8 offset:0
    ds_read_b128 v[128:131], v8 offset:2048
    v_mfma_f32_16x16x32_f16 v[16:19], v[164:167], v[176:179], v[16:19]
    ds_read_b64_tr_b16 v[136:137], v6 offset:4096
    ds_read_b64_tr_b16 v[138:139], v6 offset:4608
    v_mfma_f32_16x16x32_f16 v[20:23], v[164:167], v[180:183], v[20:23]
    ds_read_b64_tr_b16 v[140:141], v7 offset:4096
    ds_read_b64_tr_b16 v[142:143], v7 offset:4608
    v_mfma_f32_16x16x32_f16 v[24:27], v[168:171], v[176:179], v[24:27]
    v_mfma_f32_16x16x32_f16 v[28:31], v[168:171], v[180:183], v[28:31]
    s_add_u32 s53, s53, 1
    s_cmp_lt_u32 s53, 2
    s_cbranch_scc1 K3_LA1
    s_add_u32 s52, s52, 17408
    s_cmp_ge_u32 s52, 156672
    s_cselect_b32 s52, 0, s52
    v_add_u32 v5, s52, v2
    v_add_u32 v6, s52, v3
    v_add_u32 v7, s52, v4
    v_xor_b32 v8, 64, v5
    s_cmp_lg_u32 s90, s89
    s_cbranch_scc1 K3_NPF7
    buffer_load_dword v241, v240, s[84:87], s88 offen
    s_add_u32 s88, s88, 2097152
    s_add_u32 s89, s89, 8
K3_NPF7:
    s_add_u32 s90, s90, 1
    s_waitcnt lgkmcnt(12)
    s_barrier
    v_mfma_f32_16x16x32_bf16 v[40:43], v[64:67], v[76:79], 0
    ds_read_b128 v[144:147], v5 offset:0
    ds_read_b128 v[148:151], v5 offset:2048
    v_mfma_f32_16x16x32_bf16 v[44:47], v[64:67], v[80:83], 0
    ds_read_b64_tr_b16 v[156:157], v6 offset:0
    ds_read_b64_tr_b16 v[158:159], v6 offset:512
    v_mfma_f32_16x16x32_bf16 v[48:51], v[68:71], v[76:79], 0
    ds_read_b64_tr_b16 v[160:161], v7 offset:0
    ds_read_b64_tr_b16 v[162:163], v7 offset:512
    v_mfma_f32_16x16x32_bf16 v[52:55], v[68:71], v[80:83], 0
    ds_read_b128 v[164:167], v8 offset:0
    ds_read_b128 v[168:171], v8 offset:2048
    v_mfma_f32_16x16x32_bf16 v[40:43], v[84:87], v[96:99], v[40:43]
    ds_read_b64_tr_b16 v[176:177], v6 offset:4096
    ds_read_b64_tr_b16 v[178:179], v6 offset:4608
    v_mfma_f32_16x16x32_bf16 v[44:47], v[84:87], v[100:103], v[44:47]
    ds_read_b64_tr_b16 v[180:181], v7 offset:4096
    ds_read_b64_tr_b16 v[182:183], v7 offset:4608
    v_mfma_f32_16x16x32_bf16 v[48:51], v[88:91], v[96:99], v[48:51]
    v_mfma_f32_16x16x32_bf16 v[52:55], v[88:91], v[100:103], v[52:55]
    s_add_u32 s52, s52, 17408
    s_cmp_ge_u32 s52, 156672
    s_cselect_b32 s52, 0, s52
    v_add_u32 v5, s52, v2
    v_add_u32 v6, s52, v3
    v_add_u32 v7, s52, v4
    v_xor_b32 v8, 64, v5
    s_cmp_lg_u32 s90, s89
    s_cbranch_scc1 K3_NPF8
    buffer_load_dword v241, v240, s[84:87], s88 offen
    s_add_u32 s88, s88, 2097152
    s_add_u32 s89, s89, 8
K3_NPF8:
    s_add_u32 s90, s90, 1
    s_waitcnt lgkmcnt(12)
    s_barrier
    v_mfma_f32_16x16x32_bf16 v[40:43], v[104:107], v[116:119], v[40:43]
    ds_read_b128 v[64:67], v5 offset:0
    ds_read_b128 v[68:71], v5 offset:2048
    v_mfma_f32_16x16x32_bf16 v[44:47], v[104:107], v[120:123], v[44:47]
    ds_read_b64_tr_b16 v[76:77], v6 offset:0
    ds_read_b64_tr_b16 v[78:79], v6 offset:512
    v_mfma_f32_16x16x32_bf16 v[48:51], v[108:111], v[116:119], v[48:51]
    ds_read_b64_tr_b16 v[80:81], v7 offset:0
    ds_read_b64_tr_b16 v[82:83], v7 offset:512
    v_mfma_f32_16x16x32_bf16 v[52:55], v[108:111], v[120:123], v[52:55]
    ds_read_b128 v[84:87], v8 offset:0
    ds_read_b128 v[88:91], v8 offset:2048
    v_mfma_f32_16x16x32_bf16 v[40:43], v[124:127], v[136:139], v[40:43]
    ds_read_b64_tr_b16 v[96:97], v6 offset:4096
    ds_read_b64_tr_b16 v[98:99], v6 offset:4608
    v_mfma_f32_16x16x32_bf16 v[44:47], v[124:127], v[140:143], v[44:47]
    ds_read_b64_tr_b16 v[100:101], v7 offset:4096
    ds_read_b64_tr_b16 v[102:103], v7 offset:4608
    v_mfma_f32_16x16x32_bf16 v[48:51], v[128:131], v[136:139], v[48:51]
    v_mfma_f32_16x16x32_bf16 v[52:55], v[128:131], v[140:143], v[52:55]
    s_add_u32 s52, s52, 17408
    s_cmp_ge_u32 s52, 156672
    s_cselect_b32 s52, 0, s52
    v_add_u32 v5, s52, v2
    v_add_u32 v6, s52, v3
    v_add_u32 v7, s52, v4
    v_xor_b32 v8, 64, v5
    s_cmp_lg_u32 s90, s89
    s_cbranch_scc1 K3_NPF9
    buffer_load_dword v241, v240, s[84:87], s88 offen
    s_add_u32 s88, s88, 2097152
    s_add_u32 s89, s89, 8
K3_NPF9:
    s_add_u32 s90, s90, 1
    s_waitcnt lgkmcnt(12)
    s_barrier
    v_mfma_f32_16x16x32_bf16 v[40:43], v[144:147], v[156:159], v[40:43]
    ds_read_b128 v[104:107], v5 offset:0
    ds_read_b128 v[108:111], v5 offset:2048
    v_mfma_f32_16x16x32_bf16 v[44:47], v[144:147], v[160:163], v[44:47]
    ds_read_b64_tr_b16 v[116:117], v6 offset:0
    ds_read_b64_tr_b16 v[118:119], v6 offset:512
    v_mfma_f32_16x16x32_bf16 v[48:51], v[148:151], v[156:159], v[48:51]
    ds_read_b64_tr_b16 v[120:121], v7 offset:0
    ds_read_b64_tr_b16 v[122:123], v7 offset:512
    v_mfma_f32_16x16x32_bf16 v[52:55], v[148:151], v[160:163], v[52:55]
    ds_read_b128 v[124:127], v8 offset:0
    ds_read_b128 v[128:131], v8 offset:2048
    v_mfma_f32_16x16x32_bf16 v[40:43], v[164:167], v[176:179], v[40:43]
    ds_read_b64_tr_b16 v[136:137], v6 offset:4096
    ds_read_b64_tr_b16 v[138:139], v6 offset:4608
    v_mfma_f32_16x16x32_bf16 v[44:47], v[164:167], v[180:183], v[44:47]
    ds_read_b64_tr_b16 v[140:141], v7 offset:4096
    ds_read_b64_tr_b16 v[142:143], v7 offset:4608
    v_mfma_f32_16x16x32_bf16 v[48:51], v[168:171], v[176:179], v[48:51]
    v_mfma_f32_16x16x32_bf16 v[52:55], v[168:171], v[180:183], v[52:55]
    s_mov_b32 s53, 0
K3_LB1:
    s_add_u32 s52, s52, 17408
    s_cmp_ge_u32 s52, 156672
    s_cselect_b32 s52, 0, s52
    v_add_u32 v5, s52, v2
    v_add_u32 v6, s52, v3
    v_add_u32 v7, s52, v4
    v_xor_b32 v8, 64, v5
    s_cmp_lg_u32 s90, s89
    s_cbranch_scc1 K3_NPF10
    buffer_load_dword v241, v240, s[84:87], s88 offen
    s_add_u32 s88, s88, 2097152
    s_add_u32 s89, s89, 8
K3_NPF10:
    s_add_u32 s90, s90, 1
    s_waitcnt lgkmcnt(12)
    s_barrier
    v_mfma_f32_16x16x32_bf16 v[40:43], v[64:67], v[76:79], v[40:43]
    ds_read_b128 v[144:147], v5 offset:0
    ds_read_b128 v[148:151], v5 offset:2048
    v_mfma_f32_16x16x32_bf16 v[44:47], v[64:67], v[80:83], v[44:47]
    ds_read_b64_tr_b16 v[156:157], v6 offset:0
    ds_read_b64_tr_b16 v[158:159], v6 offset:512
    v_mfma_f32_16x16x32_bf16 v[48:51], v[68:71], v[76:79], v[48:51]
    ds_read_b64_tr_b16 v[160:161], v7 offset:0
    ds_read_b64_tr_b16 v[162:163], v7 offset:512
    v_mfma_f32_16x16x32_bf16 v[52:55], v[68:71], v[80:83], v[52:55]
    ds_read_b128 v[164:167], v8 offset:0
    ds_read_b128 v[168:171], v8 offset:2048
    v_mfma_f32_16x16x32_bf16 v[40:43], v[84:87], v[96:99], v[40:43]
    ds_read_b64_tr_b16 v[176:177], v6 offset:4096
    ds_read_b64_tr_b16 v[178:179], v6 offset:4608
    v_mfma_f32_16x16x32_bf16 v[44:47], v[84:87], v[100:103], v[44:47]
    ds_read_b64_tr_b16 v[180:181], v7 offset:4096
    ds_read_b64_tr_b16 v[182:183], v7 offset:4608
    v_mfma_f32_16x16x32_bf16 v[48:51], v[88:91], v[96:99], v[48:51]
    v_mfma_f32_16x16x32_bf16 v[52:55], v[88:91], v[100:103], v[52:55]
    s_add_u32 s52, s52, 17408
    s_cmp_ge_u32 s52, 156672
    s_cselect_b32 s52, 0, s52
    v_add_u32 v5, s52, v2
    v_add_u32 v6, s52, v3
    v_add_u32 v7, s52, v4
    v_xor_b32 v8, 64, v5
    s_cmp_lg_u32 s90, s89
    s_cbranch_scc1 K3_NPF11
    buffer_load_dword v241, v240, s[84:87], s88 offen
    s_add_u32 s88, s88, 2097152
    s_add_u32 s89, s89, 8
K3_NPF11:
    s_add_u32 s90, s90, 1
    s_waitcnt lgkmcnt(12)
    s_barrier
    v_mfma_f32_16x16x32_bf16 v[40:43], v[104:107], v[116:119], v[40:43]
    ds_read_b128 v[64:67], v5 offset:0
    ds_read_b128 v[68:71], v5 offset:2048
    v_mfma_f32_16x16x32_bf16 v[44:47], v[104:107], v[120:123], v[44:47]
    ds_read_b64_tr_b16 v[76:77], v6 offset:0
    ds_read_b64_tr_b16 v[78:79], v6 offset:512
    v_mfma_f32_16x16x32_bf16 v[48:51], v[108:111], v[116:119], v[48:51]
    ds_read_b64_tr_b16 v[80:81], v7 offset:0
    ds_read_b64_tr_b16 v[82:83], v7 offset:512
    v_mfma_f32_16x16x32_bf16 v[52:55], v[108:111], v[120:123], v[52:55]
    ds_read_b128 v[84:87], v8 offset:0
    ds_read_b128 v[88:91], v8 offset:2048
    v_mfma_f32_16x16x32_bf16 v[40:43], v[124:127], v[136:139], v[40:43]
    ds_read_b64_tr_b16 v[96:97], v6 offset:4096
    ds_read_b64_tr_b16 v[98:99], v6 offset:4608
    v_mfma_f32_16x16x32_bf16 v[44:47], v[124:127], v[140:143], v[44:47]
    ds_read_b64_tr_b16 v[100:101], v7 offset:4096
    ds_read_b64_tr_b16 v[102:103], v7 offset:4608
    v_mfma_f32_16x16x32_bf16 v[48:51], v[128:131], v[136:139], v[48:51]
    v_mfma_f32_16x16x32_bf16 v[52:55], v[128:131], v[140:143], v[52:55]
    s_add_u32 s52, s52, 17408
    s_cmp_ge_u32 s52, 156672
    s_cselect_b32 s52, 0, s52
    v_add_u32 v5, s52, v2
    v_add_u32 v6, s52, v3
    v_add_u32 v7, s52, v4
    v_xor_b32 v8, 64, v5
    s_cmp_lg_u32 s90, s89
    s_cbranch_scc1 K3_NPF12
    buffer_load_dword v241, v240, s[84:87], s88 offen
    s_add_u32 s88, s88, 2097152
    s_add_u32 s89, s89, 8
K3_NPF12:
    s_add_u32 s90, s90, 1
    s_waitcnt lgkmcnt(12)
    s_barrier
    v_mfma_f32_16x16x32_bf16 v[40:43], v[144:147], v[156:159], v[40:43]
    ds_read_b128 v[104:107], v5 offset:0
    ds_read_b128 v[108:111], v5 offset:2048
    v_mfma_f32_16x16x32_bf16 v[44:47], v[144:147], v[160:163], v[44:47]
    ds_read_b64_tr_b16 v[116:117], v6 offset:0
    ds_read_b64_tr_b16 v[118:119], v6 offset:512
    v_mfma_f32_16x16x32_bf16 v[48:51], v[148:151], v[156:159], v[48:51]
    ds_read_b64_tr_b16 v[120:121], v7 offset:0
    ds_read_b64_tr_b16 v[122:123], v7 offset:512
    v_mfma_f32_16x16x32_bf16 v[52:55], v[148:151], v[160:163], v[52:55]
    ds_read_b128 v[124:127], v8 offset:0
    ds_read_b128 v[128:131], v8 offset:2048
    v_mfma_f32_16x16x32_bf16 v[40:43], v[164:167], v[176:179], v[40:43]
    ds_read_b64_tr_b16 v[136:137], v6 offset:4096
    ds_read_b64_tr_b16 v[138:139], v6 offset:4608
    v_mfma_f32_16x16x32_bf16 v[44:47], v[164:167], v[180:183], v[44:47]
    ds_read_b64_tr_b16 v[140:141], v7 offset:4096
    ds_read_b64_tr_b16 v[142:143], v7 offset:4608
    v_mfma_f32_16x16x32_bf16 v[48:51], v[168:171], v[176:179], v[48:51]
    v_mfma_f32_16x16x32_bf16 v[52:55], v[168:171], v[180:183], v[52:55]
    s_add_u32 s53, s53, 1
    s_cmp_lt_u32 s53, 22
    s_cbranch_scc1 K3_LB1
    s_add_u32 s52, s52, 17408
    s_cmp_ge_u32 s52, 156672
    s_cselect_b32 s52, 0, s52
    v_add_u32 v5, s52, v2
    v_add_u32 v6, s52, v3
    v_add_u32 v7, s52, v4
    v_xor_b32 v8, 64, v5
    s_cmp_lg_u32 s90, s89
    s_cbranch_scc1 K3_NPF13
    buffer_load_dword v241, v240, s[84:87], s88 offen
    s_add_u32 s88, s88, 2097152
    s_add_u32 s89, s89, 8
K3_NPF13:
    s_add_u32 s90, s90, 1
    s_waitcnt lgkmcnt(12)
    s_barrier
    v_mfma_f32_16x16x32_bf16 v[40:43], v[64:67], v[76:79], v[40:43]
    ds_read_b128 v[144:147], v5 offset:0
    ds_read_b128 v[148:151], v5 offset:2048
    v_mfma_f32_16x16x32_bf16 v[44:47], v[64:67], v[80:83], v[44:47]
    ds_read_b64_tr_b16 v[156:157], v6 offset:0
    ds_read_b64_tr_b16 v[158:159], v6 offset:512
    v_mfma_f32_16x16x32_bf16 v[48:51], v[68:71], v[76:79], v[48:51]
    ds_read_b64_tr_b16 v[160:161], v7 offset:0
    ds_read_b64_tr_b16 v[162:163], v7 offset:512
    v_mfma_f32_16x16x32_bf16 v[52:55], v[68:71], v[80:83], v[52:55]
    ds_read_b128 v[164:167], v8 offset:0
    ds_read_b128 v[168:171], v8 offset:2048
    v_mfma_f32_16x16x32_bf16 v[40:43], v[84:87], v[96:99], v[40:43]
    ds_read_b64_tr_b16 v[176:177], v6 offset:4096
    ds_read_b64_tr_b16 v[178:179], v6 offset:4608
    v_mfma_f32_16x16x32_bf16 v[44:47], v[84:87], v[100:103], v[44:47]
    ds_read_b64_tr_b16 v[180:181], v7 offset:4096
    ds_read_b64_tr_b16 v[182:183], v7 offset:4608
    v_mfma_f32_16x16x32_bf16 v[48:51], v[88:91], v[96:99], v[48:51]
    v_mfma_f32_16x16x32_bf16 v[52:55], v[88:91], v[100:103], v[52:55]
    s_add_u32 s52, s52, 17408
    s_cmp_ge_u32 s52, 156672
    s_cselect_b32 s52, 0, s52
    v_add_u32 v5, s52, v2
    v_add_u32 v6, s52, v3
    v_add_u32 v7, s52, v4
    v_xor_b32 v8, 64, v5
    s_cmp_lg_u32 s90, s89
    s_cbranch_scc1 K3_NPF14
    buffer_load_dword v241, v240, s[84:87], s88 offen
    s_add_u32 s88, s88, 2097152
    s_add_u32 s89, s89, 8
K3_NPF14:
    s_add_u32 s90, s90, 1
    s_waitcnt lgkmcnt(12)
    s_barrier
    v_mfma_f32_16x16x32_bf16 v[40:43], v[104:107], v[116:119], v[40:43]
    ds_read_b128 v[64:67], v5 offset:0
    ds_read_b128 v[68:71], v5 offset:2048
    v_mfma_f32_16x16x32_bf16 v[44:47], v[104:107], v[120:123], v[44:47]
    ds_read_b64_tr_b16 v[76:77], v6 offset:0
    ds_read_b64_tr_b16 v[78:79], v6 offset:512
    v_mfma_f32_16x16x32_bf16 v[48:51], v[108:111], v[116:119], v[48:51]
    ds_read_b64_tr_b16 v[80:81], v7 offset:0
    ds_read_b64_tr_b16 v[82:83], v7 offset:512
    v_mfma_f32_16x16x32_bf16 v[52:55], v[108:111], v[120:123], v[52:55]
    ds_read_b128 v[84:87], v8 offset:0
    ds_read_b128 v[88:91], v8 offset:2048
    v_mfma_f32_16x16x32_bf16 v[40:43], v[124:127], v[136:139], v[40:43]
    ds_read_b64_tr_b16 v[96:97], v6 offset:4096
    ds_read_b64_tr_b16 v[98:99], v6 offset:4608
    v_mfma_f32_16x16x32_bf16 v[44:47], v[124:127], v[140:143], v[44:47]
    ds_read_b64_tr_b16 v[100:101], v7 offset:4096
    ds_read_b64_tr_b16 v[102:103], v7 offset:4608
    v_mfma_f32_16x16x32_bf16 v[48:51], v[128:131], v[136:139], v[48:51]
    v_mfma_f32_16x16x32_bf16 v[52:55], v[128:131], v[140:143], v[52:55]
    v_and_b32 v9, 15, v1
    v_lshrrev_b32 v10, 4, v1
    v_mul_u32_u24 v11, 1152, v9
    v_lshl_add_u32 v11, v10, 3, v11
    s_lshl_b32 s54, s36, 6
    s_lshl_b32 s55, s41, 5
    s_add_u32 s54, s54, s55
    s_mul_i32 s54, s54, 1152
    s_lshl_b32 s55, s39, 1
    s_add_u32 s54, s54, s55
    s_add_u32 s54, s54, 96
    s_add_u32 s55, s54, 0
    buffer_load_dwordx2 v[200:201], v11, s[20:23], s55 offen
    s_add_u32 s55, s54, 18432
    buffer_load_dwordx2 v[202:203], v11, s[20:23], s55 offen
    s_add_u32 s55, s54, 32
    buffer_load_dwordx2 v[204:205], v11, s[20:23], s55 offen
    s_add_u32 s55, s54, 18464
    buffer_load_dwordx2 v[206:207], v11, s[20:23], s55 offen
    v_lshlrev_b32 v12, 1, v9
    s_lshl_b32 s55, s41, 6
    s_add_u32 s55, s55, s38
    buffer_load_ushort v220, v12, s[32:35], s55 offen offset:0
    buffer_load_ushort v221, v12, s[32:35], s55 offen offset:32
    s_add_u32 s52, s52, 17408
    s_cmp_ge_u32 s52, 156672
    s_cselect_b32 s52, 0, s52
    v_add_u32 v5, s52, v2
    v_add_u32 v6, s52, v3
    v_add_u32 v7, s52, v4
    v_xor_b32 v8, 64, v5
    s_cmp_lg_u32 s90, s89
    s_cbranch_scc1 K3_NPF15
    buffer_load_dword v241, v240, s[84:87], s88 offen
    s_add_u32 s88, s88, 2097152
    s_add_u32 s89, s89, 8
K3_NPF15:
    s_add_u32 s90, s90, 1
    s_waitcnt lgkmcnt(12)
    s_barrier
    v_mfma_f32_16x16x32_bf16 v[40:43], v[144:147], v[156:159], v[40:43]
    ds_read_b128 v[104:107], v5 offset:0
    ds_read_b128 v[108:111], v5 offset:2048
    v_mfma_f32_16x16x32_bf16 v[44:47], v[144:147], v[160:163], v[44:47]
    ds_read_b64_tr_b16 v[116:117], v6 offset:0
    ds_read_b64_tr_b16 v[118:119], v6 offset:512
    v_mfma_f32_16x16x32_bf16 v[48:51], v[148:151], v[156:159], v[48:51]
    ds_read_b64_tr_b16 v[120:121], v7 offset:0
    ds_read_b64_tr_b16 v[122:123], v7 offset:512
    v_mfma_f32_16x16x32_bf16 v[52:55], v[148:151], v[160:163], v[52:55]
    ds_read_b128 v[124:127], v8 offset:0
    ds_read_b128 v[128:131], v8 offset:2048
    v_mfma_f32_16x16x32_bf16 v[40:43], v[164:167], v[176:179], v[40:43]
    ds_read_b64_tr_b16 v[136:137], v6 offset:4096
    ds_read_b64_tr_b16 v[138:139], v6 offset:4608
    v_mfma_f32_16x16x32_bf16 v[44:47], v[164:167], v[180:183], v[44:47]
    ds_read_b64_tr_b16 v[140:141], v7 offset:4096
    ds_read_b64_tr_b16 v[142:143], v7 offset:4608
    v_mfma_f32_16x16x32_bf16 v[48:51], v[168:171], v[176:179], v[48:51]
    v_mfma_f32_16x16x32_bf16 v[52:55], v[168:171], v[180:183], v[52:55]
    s_waitcnt vmcnt(0)
    v_lshlrev_b32 v220, 16, v220
    v_lshlrev_b32 v221, 16, v221
    v_cmp_gt_u32 vcc, 2, v10
    v_cvt_pk_bf16_f32 v224, v16, v17
    v_cvt_pk_bf16_f32 v225, v18, v19
    v_cvt_pk_bf16_f32 v226, v40, v41
    v_cvt_pk_bf16_f32 v227, v42, v43
    v_lshlrev_b32 v16, 16, v224
    v_and_b32 v17, 0xffff0000, v224
    v_lshlrev_b32 v18, 16, v225
    v_and_b32 v19, 0xffff0000, v225
    v_lshlrev_b32 v40, 16, v226
    v_and_b32 v41, 0xffff0000, v226
    v_lshlrev_b32 v42, 16, v227
    v_and_b32 v43, 0xffff0000, v227
    v_lshlrev_b32 v228, 16, v200
    v_and_b32 v229, 0xffff0000, v200
    v_lshlrev_b32 v230, 16, v201
    v_and_b32 v231, 0xffff0000, v201
    v_pk_add_f32 v[16:17], v[16:17], v[228:229]
    v_pk_add_f32 v[18:19], v[18:19], v[230:231]
    v_add_f32 v40, v40, v220
    v_add_f32 v41, v41, v220
    v_add_f32 v42, v42, v220
    v_add_f32 v43, v43, v220
    v_cvt_pk_bf16_f32 v224, v16, v17
    v_cvt_pk_bf16_f32 v225, v18, v19
    v_cvt_pk_bf16_f32 v226, v40, v41
    v_cvt_pk_bf16_f32 v227, v42, v43
    v_lshlrev_b32 v16, 16, v224
    v_and_b32 v17, 0xffff0000, v224
    v_lshlrev_b32 v18, 16, v225
    v_and_b32 v19, 0xffff0000, v225
    v_lshlrev_b32 v40, 16, v226
    v_and_b32 v41, 0xffff0000, v226
    v_lshlrev_b32 v42, 16, v227
    v_and_b32 v43, 0xffff0000, v227
    v_pk_add_f32 v[16:17], v[16:17], v[40:41]
    v_pk_add_f32 v[18:19], v[18:19], v[42:43]
    v_cvt_pk_bf16_f32 v16, v16, v17
    v_cvt_pk_bf16_f32 v17, v18, v19
    s_add_u32 s55, s54, 0
    buffer_store_dwordx2 v[16:17], v11, s[24:27], s55 offen
    v_cvt_pk_bf16_f32 v224, v20, v21
    v_cvt_pk_bf16_f32 v225, v22, v23
    v_cvt_pk_bf16_f32 v226, v44, v45
    v_cvt_pk_bf16_f32 v227, v46, v47
    v_lshlrev_b32 v20, 16, v224
    v_and_b32 v21, 0xffff0000, v224
    v_lshlrev_b32 v22, 16, v225
    v_and_b32 v23, 0xffff0000, v225
    v_lshlrev_b32 v44, 16, v226
    v_and_b32 v45, 0xffff0000, v226
    v_lshlrev_b32 v46, 16, v227
    v_and_b32 v47, 0xffff0000, v227
    v_lshlrev_b32 v228, 16, v202
    v_and_b32 v229, 0xffff0000, v202
    v_lshlrev_b32 v230, 16, v203
    v_and_b32 v231, 0xffff0000, v203
    v_pk_add_f32 v[20:21], v[20:21], v[228:229]
    v_pk_add_f32 v[22:23], v[22:23], v[230:231]
    v_add_f32 v44, v44, v221
    v_add_f32 v45, v45, v221
    v_add_f32 v46, v46, v221
    v_add_f32 v47, v47, v221
    v_cvt_pk_bf16_f32 v224, v20, v21
    v_cvt_pk_bf16_f32 v225, v22, v23
    v_cvt_pk_bf16_f32 v226, v44, v45
    v_cvt_pk_bf16_f32 v227, v46, v47
    v_lshlrev_b32 v20, 16, v224
    v_and_b32 v21, 0xffff0000, v224
    v_lshlrev_b32 v22, 16, v225
    v_and_b32 v23, 0xffff0000, v225
    v_lshlrev_b32 v44, 16, v226
    v_and_b32 v45, 0xffff0000, v226
    v_lshlrev_b32 v46, 16, v227
    v_and_b32 v47, 0xffff0000, v227
    v_pk_add_f32 v[20:21], v[20:21], v[44:45]
    v_pk_add_f32 v[22:23], v[22:23], v[46:47]
    v_cvt_pk_bf16_f32 v20, v20, v21
    v_cvt_pk_bf16_f32 v21, v22, v23
    s_add_u32 s55, s54, 18432
    buffer_store_dwordx2 v[20:21], v11, s[24:27], s55 offen
    v_cvt_pk_bf16_f32 v224, v24, v25
    v_cvt_pk_bf16_f32 v225, v26, v27
    v_cvt_pk_bf16_f32 v226, v48, v49
    v_cvt_pk_bf16_f32 v227, v50, v51
    v_lshlrev_b32 v24, 16, v224
    v_and_b32 v25, 0xffff0000, v224
    v_lshlrev_b32 v26, 16, v225
    v_and_b32 v27, 0xffff0000, v225
    v_lshlrev_b32 v48, 16, v226
    v_and_b32 v49, 0xffff0000, v226
    v_lshlrev_b32 v50, 16, v227
    v_and_b32 v51, 0xffff0000, v227
    v_lshlrev_b32 v228, 16, v204
    v_and_b32 v229, 0xffff0000, v204
    v_lshlrev_b32 v230, 16, v205
    v_and_b32 v231, 0xffff0000, v205
    v_pk_add_f32 v[24:25], v[24:25], v[228:229]
    v_pk_add_f32 v[26:27], v[26:27], v[230:231]
    v_add_f32 v48, v48, v220
    v_add_f32 v49, v49, v220
    v_add_f32 v50, v50, v220
    v_add_f32 v51, v51, v220
    v_cvt_pk_bf16_f32 v224, v24, v25
    v_cvt_pk_bf16_f32 v225, v26, v27
    v_cvt_pk_bf16_f32 v226, v48, v49
    v_cvt_pk_bf16_f32 v227, v50, v51
    v_lshlrev_b32 v24, 16, v224
    v_and_b32 v25, 0xffff0000, v224
    v_lshlrev_b32 v26, 16, v225
    v_and_b32 v27, 0xffff0000, v225
    v_lshlrev_b32 v48, 16, v226
    v_and_b32 v49, 0xffff0000, v226
    v_lshlrev_b32 v50, 16, v227
    v_and_b32 v51, 0xffff0000, v227
    v_pk_add_f32 v[24:25], v[24:25], v[48:49]
    v_pk_add_f32 v[26:27], v[26:27], v[50:51]
    v_cvt_pk_bf16_f32 v24, v24, v25
    v_cvt_pk_bf16_f32 v25, v26, v27
    s_add_u32 s55, s54, 32
    s_and_saveexec_b64 s[58:59], vcc
    buffer_store_dwordx2 v[24:25], v11, s[24:27], s55 offen
    s_mov_b64 exec, s[58:59]
    v_cvt_pk_bf16_f32 v224, v28, v29
    v_cvt_pk_bf16_f32 v225, v30, v31
    v_cvt_pk_bf16_f32 v226, v52, v53
    v_cvt_pk_bf16_f32 v227, v54, v55
    v_lshlrev_b32 v28, 16, v224
    v_and_b32 v29, 0xffff0000, v224
    v_lshlrev_b32 v30, 16, v225
    v_and_b32 v31, 0xffff0000, v225
    v_lshlrev_b32 v52, 16, v226
    v_and_b32 v53, 0xffff0000, v226
    v_lshlrev_b32 v54, 16, v227
    v_and_b32 v55, 0xffff0000, v227
    v_lshlrev_b32 v228, 16, v206
    v_and_b32 v229, 0xffff0000, v206
    v_lshlrev_b32 v230, 16, v207
    v_and_b32 v231, 0xffff0000, v207
    v_pk_add_f32 v[28:29], v[28:29], v[228:229]
    v_pk_add_f32 v[30:31], v[30:31], v[230:231]
    v_add_f32 v52, v52, v221
    v_add_f32 v53, v53, v221
    v_add_f32 v54, v54, v221
    v_add_f32 v55, v55, v221
    v_cvt_pk_bf16_f32 v224, v28, v29
    v_cvt_pk_bf16_f32 v225, v30, v31
    v_cvt_pk_bf16_f32 v226, v52, v53
    v_cvt_pk_bf16_f32 v227, v54, v55
    v_lshlrev_b32 v28, 16, v224
    v_and_b32 v29, 0xffff0000, v224
    v_lshlrev_b32 v30, 16, v225
    v_and_b32 v31, 0xffff0000, v225
    v_lshlrev_b32 v52, 16, v226
    v_and_b32 v53, 0xffff0000, v226
    v_lshlrev_b32 v54, 16, v227
    v_and_b32 v55, 0xffff0000, v227
    v_pk_add_f32 v[28:29], v[28:29], v[52:53]
    v_pk_add_f32 v[30:31], v[30:31], v[54:55]
    v_cvt_pk_bf16_f32 v28, v28, v29
    v_cvt_pk_bf16_f32 v29, v30, v31
    s_add_u32 s55, s54, 18464
    s_and_saveexec_b64 s[58:59], vcc
    buffer_store_dwordx2 v[28:29], v11, s[24:27], s55 offen
    s_mov_b64 exec, s[58:59]
    s_endpgm
K3_END:
    s_endpgm
.section .rodata,"a"
.p2align 6
.amdhsa_kernel k1_kernel
  .amdhsa_next_free_vgpr 128
  .amdhsa_next_free_sgpr 102
  .amdhsa_accum_offset 128
  .amdhsa_group_segment_fixed_size 0
  .amdhsa_kernarg_size 88
  .amdhsa_user_sgpr_count 2
  .amdhsa_user_sgpr_kernarg_segment_ptr 1
  .amdhsa_system_sgpr_workgroup_id_x 1
.end_amdhsa_kernel

.amdhsa_kernel k2_kernel
  .amdhsa_next_free_vgpr 256
  .amdhsa_next_free_sgpr 102
  .amdhsa_accum_offset 256
  .amdhsa_group_segment_fixed_size 0
  .amdhsa_kernarg_size 88
  .amdhsa_user_sgpr_count 2
  .amdhsa_user_sgpr_kernarg_segment_ptr 1
  .amdhsa_system_sgpr_workgroup_id_x 1
.end_amdhsa_kernel

.amdhsa_kernel k3_kernel
  .amdhsa_next_free_vgpr 248
  .amdhsa_next_free_sgpr 102
  .amdhsa_accum_offset 248
  .amdhsa_group_segment_fixed_size 0
  .amdhsa_kernarg_size 88
  .amdhsa_user_sgpr_count 2
  .amdhsa_user_sgpr_kernarg_segment_ptr 1
  .amdhsa_system_sgpr_workgroup_id_x 1
.end_amdhsa_kernel
```
